```python
import torch

def _softmax(x, axis=-1):
    return torch.softmax(x, dim=axis)
def _gelu(x):
    return torch.nn.functional.gelu(x, approximate="tanh")
def _silu(x):
    return torch.nn.functional.silu(x)
def _sigmoid(x):
    return torch.sigmoid(x)
def _layernorm(x, axis=-1, eps=1e-5):
    m = x.mean(dim=axis, keepdim=True)
    v = x.var(dim=axis, keepdim=True, unbiased=False)
    return (x - m) / torch.sqrt(v + eps)
def _scatter_add(tgt, idx, src, axis=0):
    return tgt.clone().index_add_(axis, idx, src)
def _segment_sum(src, seg, n):
    out = torch.zeros((n,) + src.shape[1:], dtype=src.dtype)
    return out.index_add_(0, seg, src)
def _pad(x, pw):
    flat = tuple(v for pair in reversed(pw) for v in pair)
    return torch.nn.functional.pad(x, flat)

kernel_name = 'standalone__mha_softmax__sampling'

def setup_inputs():

    _w = (lambda a: (lambda t: t.to(torch.bfloat16) if t.is_floating_point() else t)(torch.as_tensor(a)))
    B, H, Sq, Sk, D = 32, 32, 1, 2048, 128
    return {
        "q": _w((lambda *s: torch.randn(*s, dtype=torch.bfloat16) * 0.8)(B, H, Sq, D)),
        "k": _w((lambda *s: torch.randn(*s, dtype=torch.bfloat16) * 0.8)(B, H, Sk, D)),
        "v": _w((lambda *s: torch.randn(*s, dtype=torch.bfloat16) * 0.05)(B, H, Sk, D)),
    }

def reference(q, k, v):
    scale = q.shape[-1] ** -0.5
    scores = torch.einsum("bhqd,bhkd->bhqk", q, k) * scale
    p = _softmax(scores, axis=-1)
    return torch.einsum("bhqk,bhkd->bhqd", p, v)
```

```asm
; @launch grid=(256,1,1) block=(256,1,1) lds=90000
.amdgcn_target "amdgcn-amd-amdhsa--gfx950"
.text
.globl standalone__mha_softmax__sampling_kernel
.p2align 8
.type standalone__mha_softmax__sampling_kernel,@function
standalone__mha_softmax__sampling_kernel:
  s_cmp_ge_u32 s2, 256
  s_cbranch_scc1 L_end
  s_load_dwordx8 s[4:11], s[0:1], 0
  s_lshr_b32 s35, s2, 3
  s_add_u32 s35, s35, s2
  s_and_b32 s35, s35, 7
  s_and_b32 s2, s2, 0xfffffff8
  s_or_b32 s2, s2, s35
  v_lshrrev_b32 v1, 6, v0
  v_and_b32 v2, 63, v0
  v_readfirstlane_b32 s33, v1
  v_lshlrev_b32 v30, 4, v2
  v_and_b32 v3, 15, v0
  v_lshlrev_b32 v31, 4, v3
  s_lshl_b32 s43, s2, 19
  s_lshl_b32 s35, s33, 11
  s_sub_u32 s42, 524288, s35
  s_add_u32 s43, s43, s35
  s_mov_b32 s14, s42
  s_mov_b32 s15, 0x00020000
  s_mov_b32 s26, 262144
  s_mov_b32 s27, 0x00020000
  s_lshl_b32 s41, s2, 8
  s_waitcnt lgkmcnt(0)
  s_add_u32 s12, s6, s43
  s_addc_u32 s13, s7, 0
  s_and_b32 s13, s13, 0xffff
  s_mov_b32 s24, s4
  s_and_b32 s25, s5, 0xffff
  buffer_load_dwordx4 v[32:35], v31, s[24:27], s41 offen
  buffer_load_dwordx4 v[60:63], v30, s[12:15], 0 offen offset:0 nt
  buffer_load_dwordx4 v[64:67], v30, s[12:15], 0 offen offset:1024 nt
  s_mov_b32 s35, 8192
  buffer_load_dwordx4 v[68:71], v30, s[12:15], s35 offen offset:0 nt
  s_mov_b32 s35, 8192
  buffer_load_dwordx4 v[72:75], v30, s[12:15], s35 offen offset:1024 nt
  s_mov_b32 s35, 16384
  buffer_load_dwordx4 v[76:79], v30, s[12:15], s35 offen offset:0 nt
  s_mov_b32 s35, 16384
  buffer_load_dwordx4 v[80:83], v30, s[12:15], s35 offen offset:1024 nt
  s_mov_b32 s20, s12
  s_mov_b32 s21, s13
  s_add_u32 s22, s8, s43
  s_addc_u32 s23, s9, 0
  s_and_b32 s23, s23, 0xffff
  s_mov_b32 s32, 0
  s_add_u32 s35, s32, 1
  s_cmp_ge_u32 s35, 4
  s_cselect_b32 s16, s22, s20
  s_cselect_b32 s17, s23, s21
  s_and_b32 s43, s35, 3
  s_mul_i32 s43, s43, 134217728
  s_add_u32 s16, s16, s43
  s_addc_u32 s17, s17, 0
  s_cmp_ge_u32 s35, 8
  s_cselect_b32 s18, 0, s42
  s_mov_b32 s19, 0x00020000
  s_mov_b32 s28, s10
  s_and_b32 s29, s11, 0xffff
  s_mov_b32 s30, 262144
  s_mov_b32 s31, 0x00020000
  s_mov_b32 s48, 0x01010101
  s_mov_b32 s49, 0x01010101
  s_mov_b32 s50, 0x02020202
  s_mov_b32 s51, 0x02020202
  s_mov_b32 s52, 0x04040404
  s_mov_b32 s53, 0x04040404
  s_mov_b32 s54, 0x08080808
  s_mov_b32 s55, 0x08080808
  s_mov_b32 s56, 0x10101010
  s_mov_b32 s57, 0x10101010
  s_mov_b32 s58, 0x20202020
  s_mov_b32 s59, 0x20202020
  s_mov_b32 s60, 0x40404040
  s_mov_b32 s61, 0x40404040
  s_mov_b32 s62, 0x80808080
  s_mov_b32 s63, 0x80808080
  v_and_b32 v1, 1, v0
  v_lshlrev_b32 v1, 4, v1
  v_mov_b32 v2, 0xffff
  v_lshlrev_b32 v2, v1, v2
  v_bfe_u32 v1, v0, 1, 2
  v_cmp_eq_u32 vcc, 0, v1
  s_nop 1
  v_cndmask_b32 v8, 0, v2, vcc
  v_cmp_eq_u32 vcc, 1, v1
  s_nop 1
  v_cndmask_b32 v9, 0, v2, vcc
  v_cmp_eq_u32 vcc, 2, v1
  s_nop 1
  v_cndmask_b32 v10, 0, v2, vcc
  v_cmp_eq_u32 vcc, 3, v1
  s_nop 1
  v_cndmask_b32 v11, 0, v2, vcc
  v_mov_b32 v40, 0
  v_mov_b32 v41, 0
  v_mov_b32 v42, 0
  v_mov_b32 v43, 0
  v_mov_b32 v44, 0
  v_mov_b32 v45, 0
  v_mov_b32 v46, 0
  v_mov_b32 v47, 0
  s_mov_b32 s34, 0x3e0293ee
  s_mov_b32 s40, 0
  s_mul_i32 s35, s33, 2048
  s_add_u32 s35, s35, 16896
  v_add_u32 v37, s35, v30
L_khead:
  s_waitcnt vmcnt(4)
  v_mov_b32 v4, v32
  v_mov_b32 v5, v33
  v_mov_b32 v6, v34
  v_mov_b32 v7, v35
  s_add_u32 s41, s41, 65536
  s_min_u32 s35, s41, 0x3ff00
  buffer_load_dwordx4 v[32:35], v31, s[24:27], s35 offen
  v_dot2_f32_bf16 v28, v60, v4, 0
  v_dot2_f32_bf16 v29, v64, v4, 0
  v_dot2_f32_bf16 v28, v61, v5, v28
  v_dot2_f32_bf16 v29, v65, v5, v29
  v_dot2_f32_bf16 v28, v62, v6, v28
  v_dot2_f32_bf16 v29, v66, v6, v29
  v_dot2_f32_bf16 v28, v63, v7, v28
  v_dot2_f32_bf16 v29, v67, v7, v29
  s_mov_b32 s35, 24576
  buffer_load_dwordx4 v[84:87], v30, s[12:15], s35 offen offset:0 nt
  s_nop 0
  v_add_f32_dpp v36, v28, v28 row_ror:8 row_mask:0xf bank_mask:0x3
  v_add_f32_dpp v36, v29, v29 row_ror:8 row_mask:0xf bank_mask:0xc
  s_nop 1
  v_add_f32_dpp v36, v36, v36 row_half_mirror row_mask:0xf bank_mask:0xf
  s_nop 1
  v_add_f32_dpp v36, v36, v36 quad_perm:[1,0,3,2] row_mask:0xf bank_mask:0xf
  s_nop 1
  v_add_f32_dpp v36, v36, v36 quad_perm:[2,3,0,1] row_mask:0xf bank_mask:0xf
  v_cndmask_b32 v40, v40, v36, s[48:49]
  s_waitcnt vmcnt(3)
  v_dot2_f32_bf16 v28, v68, v4, 0
  v_dot2_f32_bf16 v29, v72, v4, 0
  v_dot2_f32_bf16 v28, v69, v5, v28
  v_dot2_f32_bf16 v29, v73, v5, v29
  v_dot2_f32_bf16 v28, v70, v6, v28
  v_dot2_f32_bf16 v29, v74, v6, v29
  v_dot2_f32_bf16 v28, v71, v7, v28
  v_dot2_f32_bf16 v29, v75, v7, v29
  s_mov_b32 s35, 24576
  buffer_load_dwordx4 v[88:91], v30, s[12:15], s35 offen offset:1024 nt
  s_mov_b32 s35, 32768
  buffer_load_dwordx4 v[92:95], v30, s[12:15], s35 offen offset:0 nt
  s_mov_b32 s35, 32768
  buffer_load_dwordx4 v[96:99], v30, s[12:15], s35 offen offset:1024 nt
  s_nop 0
  v_add_f32_dpp v36, v28, v28 row_ror:8 row_mask:0xf bank_mask:0x3
  v_add_f32_dpp v36, v29, v29 row_ror:8 row_mask:0xf bank_mask:0xc
  s_nop 1
  v_add_f32_dpp v36, v36, v36 row_half_mirror row_mask:0xf bank_mask:0xf
  s_nop 1
  v_add_f32_dpp v36, v36, v36 quad_perm:[1,0,3,2] row_mask:0xf bank_mask:0xf
  s_nop 1
  v_add_f32_dpp v36, v36, v36 quad_perm:[2,3,0,1] row_mask:0xf bank_mask:0xf
  v_cndmask_b32 v40, v40, v36, s[50:51]
  s_waitcnt vmcnt(4)
  v_dot2_f32_bf16 v28, v76, v4, 0
  v_dot2_f32_bf16 v29, v80, v4, 0
  v_dot2_f32_bf16 v28, v77, v5, v28
  v_dot2_f32_bf16 v29, v81, v5, v29
  v_dot2_f32_bf16 v28, v78, v6, v28
  v_dot2_f32_bf16 v29, v82, v6, v29
  v_dot2_f32_bf16 v28, v79, v7, v28
  v_dot2_f32_bf16 v29, v83, v7, v29
  s_mov_b32 s35, 40960
  buffer_load_dwordx4 v[100:103], v30, s[12:15], s35 offen offset:0 nt
  s_mov_b32 s35, 40960
  buffer_load_dwordx4 v[104:107], v30, s[12:15], s35 offen offset:1024 nt
  s_nop 0
  v_add_f32_dpp v36, v28, v28 row_ror:8 row_mask:0xf bank_mask:0x3
  v_add_f32_dpp v36, v29, v29 row_ror:8 row_mask:0xf bank_mask:0xc
  s_nop 1
  v_add_f32_dpp v36, v36, v36 row_half_mirror row_mask:0xf bank_mask:0xf
  s_nop 1
  v_add_f32_dpp v36, v36, v36 quad_perm:[1,0,3,2] row_mask:0xf bank_mask:0xf
  s_nop 1
  v_add_f32_dpp v36, v36, v36 quad_perm:[2,3,0,1] row_mask:0xf bank_mask:0xf
  v_cndmask_b32 v40, v40, v36, s[52:53]
  s_waitcnt vmcnt(4)
  v_dot2_f32_bf16 v28, v84, v4, 0
  v_dot2_f32_bf16 v29, v88, v4, 0
  v_dot2_f32_bf16 v28, v85, v5, v28
  v_dot2_f32_bf16 v29, v89, v5, v29
  v_dot2_f32_bf16 v28, v86, v6, v28
  v_dot2_f32_bf16 v29, v90, v6, v29
  v_dot2_f32_bf16 v28, v87, v7, v28
  v_dot2_f32_bf16 v29, v91, v7, v29
  s_mov_b32 s35, 49152
  buffer_load_dwordx4 v[108:111], v30, s[12:15], s35 offen offset:0 nt
  s_mov_b32 s35, 49152
  buffer_load_dwordx4 v[112:115], v30, s[12:15], s35 offen offset:1024 nt
  s_nop 0
  v_add_f32_dpp v36, v28, v28 row_ror:8 row_mask:0xf bank_mask:0x3
  v_add_f32_dpp v36, v29, v29 row_ror:8 row_mask:0xf bank_mask:0xc
  s_nop 1
  v_add_f32_dpp v36, v36, v36 row_half_mirror row_mask:0xf bank_mask:0xf
  s_nop 1
  v_add_f32_dpp v36, v36, v36 quad_perm:[1,0,3,2] row_mask:0xf bank_mask:0xf
  s_nop 1
  v_add_f32_dpp v36, v36, v36 quad_perm:[2,3,0,1] row_mask:0xf bank_mask:0xf
  v_cndmask_b32 v40, v40, v36, s[54:55]
  s_waitcnt vmcnt(4)
  v_dot2_f32_bf16 v28, v92, v4, 0
  v_dot2_f32_bf16 v29, v96, v4, 0
  v_dot2_f32_bf16 v28, v93, v5, v28
  v_dot2_f32_bf16 v29, v97, v5, v29
  v_dot2_f32_bf16 v28, v94, v6, v28
  v_dot2_f32_bf16 v29, v98, v6, v29
  v_dot2_f32_bf16 v28, v95, v7, v28
  v_dot2_f32_bf16 v29, v99, v7, v29
  s_mov_b32 s35, 57344
  buffer_load_dwordx4 v[116:119], v30, s[12:15], s35 offen offset:0 nt
  s_mov_b32 s35, 57344
  buffer_load_dwordx4 v[120:123], v30, s[12:15], s35 offen offset:1024 nt
  s_nop 0
  v_add_f32_dpp v36, v28, v28 row_ror:8 row_mask:0xf bank_mask:0x3
  v_add_f32_dpp v36, v29, v29 row_ror:8 row_mask:0xf bank_mask:0xc
  s_nop 1
  v_add_f32_dpp v36, v36, v36 row_half_mirror row_mask:0xf bank_mask:0xf
  s_nop 1
  v_add_f32_dpp v36, v36, v36 quad_perm:[1,0,3,2] row_mask:0xf bank_mask:0xf
  s_nop 1
  v_add_f32_dpp v36, v36, v36 quad_perm:[2,3,0,1] row_mask:0xf bank_mask:0xf
  v_cndmask_b32 v40, v40, v36, s[56:57]
  s_waitcnt vmcnt(4)
  v_dot2_f32_bf16 v28, v100, v4, 0
  v_dot2_f32_bf16 v29, v104, v4, 0
  v_dot2_f32_bf16 v28, v101, v5, v28
  v_dot2_f32_bf16 v29, v105, v5, v29
  v_dot2_f32_bf16 v28, v102, v6, v28
  v_dot2_f32_bf16 v29, v106, v6, v29
  v_dot2_f32_bf16 v28, v103, v7, v28
  v_dot2_f32_bf16 v29, v107, v7, v29
  s_mov_b32 s35, 65536
  buffer_load_dwordx4 v[60:63], v30, s[12:15], s35 offen offset:0 nt
  s_nop 0
  v_add_f32_dpp v36, v28, v28 row_ror:8 row_mask:0xf bank_mask:0x3
  v_add_f32_dpp v36, v29, v29 row_ror:8 row_mask:0xf bank_mask:0xc
  s_nop 1
  v_add_f32_dpp v36, v36, v36 row_half_mirror row_mask:0xf bank_mask:0xf
  s_nop 1
  v_add_f32_dpp v36, v36, v36 quad_perm:[1,0,3,2] row_mask:0xf bank_mask:0xf
  s_nop 1
  v_add_f32_dpp v36, v36, v36 quad_perm:[2,3,0,1] row_mask:0xf bank_mask:0xf
  v_cndmask_b32 v40, v40, v36, s[58:59]
  s_waitcnt vmcnt(3)
  v_dot2_f32_bf16 v28, v108, v4, 0
  v_dot2_f32_bf16 v29, v112, v4, 0
  v_dot2_f32_bf16 v28, v109, v5, v28
  v_dot2_f32_bf16 v29, v113, v5, v29
  v_dot2_f32_bf16 v28, v110, v6, v28
  v_dot2_f32_bf16 v29, v114, v6, v29
  v_dot2_f32_bf16 v28, v111, v7, v28
  v_dot2_f32_bf16 v29, v115, v7, v29
  s_mov_b32 s35, 65536
  buffer_load_dwordx4 v[64:67], v30, s[12:15], s35 offen offset:1024 nt
  s_mov_b32 s35, 73728
  buffer_load_dwordx4 v[68:71], v30, s[12:15], s35 offen offset:0 nt
  s_mov_b32 s35, 73728
  buffer_load_dwordx4 v[72:75], v30, s[12:15], s35 offen offset:1024 nt
  s_nop 0
  v_add_f32_dpp v36, v28, v28 row_ror:8 row_mask:0xf bank_mask:0x3
  v_add_f32_dpp v36, v29, v29 row_ror:8 row_mask:0xf bank_mask:0xc
  s_nop 1
  v_add_f32_dpp v36, v36, v36 row_half_mirror row_mask:0xf bank_mask:0xf
  s_nop 1
  v_add_f32_dpp v36, v36, v36 quad_perm:[1,0,3,2] row_mask:0xf bank_mask:0xf
  s_nop 1
  v_add_f32_dpp v36, v36, v36 quad_perm:[2,3,0,1] row_mask:0xf bank_mask:0xf
  v_cndmask_b32 v40, v40, v36, s[60:61]
  s_waitcnt vmcnt(4)
  v_dot2_f32_bf16 v28, v116, v4, 0
  v_dot2_f32_bf16 v29, v120, v4, 0
  v_dot2_f32_bf16 v28, v117, v5, v28
  v_dot2_f32_bf16 v29, v121, v5, v29
  v_dot2_f32_bf16 v28, v118, v6, v28
  v_dot2_f32_bf16 v29, v122, v6, v29
  v_dot2_f32_bf16 v28, v119, v7, v28
  v_dot2_f32_bf16 v29, v123, v7, v29
  s_mov_b32 s35, 81920
  buffer_load_dwordx4 v[76:79], v30, s[12:15], s35 offen offset:0 nt
  s_mov_b32 s35, 81920
  buffer_load_dwordx4 v[80:83], v30, s[12:15], s35 offen offset:1024 nt
  s_nop 0
  v_add_f32_dpp v36, v28, v28 row_ror:8 row_mask:0xf bank_mask:0x3
  v_add_f32_dpp v36, v29, v29 row_ror:8 row_mask:0xf bank_mask:0xc
  s_nop 1
  v_add_f32_dpp v36, v36, v36 row_half_mirror row_mask:0xf bank_mask:0xf
  s_nop 1
  v_add_f32_dpp v36, v36, v36 quad_perm:[1,0,3,2] row_mask:0xf bank_mask:0xf
  s_nop 1
  v_add_f32_dpp v36, v36, v36 quad_perm:[2,3,0,1] row_mask:0xf bank_mask:0xf
  v_cndmask_b32 v40, v40, v36, s[62:63]
  s_waitcnt vmcnt(4)
  v_dot2_f32_bf16 v28, v60, v4, 0
  v_dot2_f32_bf16 v29, v64, v4, 0
  v_dot2_f32_bf16 v28, v61, v5, v28
  v_dot2_f32_bf16 v29, v65, v5, v29
  v_dot2_f32_bf16 v28, v62, v6, v28
  v_dot2_f32_bf16 v29, v66, v6, v29
  v_dot2_f32_bf16 v28, v63, v7, v28
  v_dot2_f32_bf16 v29, v67, v7, v29
  s_mov_b32 s35, 90112
  buffer_load_dwordx4 v[84:87], v30, s[12:15], s35 offen offset:0 nt
  s_mov_b32 s35, 90112
  buffer_load_dwordx4 v[88:91], v30, s[12:15], s35 offen offset:1024 nt
  s_nop 0
  v_add_f32_dpp v36, v28, v28 row_ror:8 row_mask:0xf bank_mask:0x3
  v_add_f32_dpp v36, v29, v29 row_ror:8 row_mask:0xf bank_mask:0xc
  s_nop 1
  v_add_f32_dpp v36, v36, v36 row_half_mirror row_mask:0xf bank_mask:0xf
  s_nop 1
  v_add_f32_dpp v36, v36, v36 quad_perm:[1,0,3,2] row_mask:0xf bank_mask:0xf
  s_nop 1
  v_add_f32_dpp v36, v36, v36 quad_perm:[2,3,0,1] row_mask:0xf bank_mask:0xf
  v_cndmask_b32 v41, v41, v36, s[48:49]
  s_waitcnt vmcnt(4)
  v_dot2_f32_bf16 v28, v68, v4, 0
  v_dot2_f32_bf16 v29, v72, v4, 0
  v_dot2_f32_bf16 v28, v69, v5, v28
  v_dot2_f32_bf16 v29, v73, v5, v29
  v_dot2_f32_bf16 v28, v70, v6, v28
  v_dot2_f32_bf16 v29, v74, v6, v29
  v_dot2_f32_bf16 v28, v71, v7, v28
  v_dot2_f32_bf16 v29, v75, v7, v29
  s_mov_b32 s35, 98304
  buffer_load_dwordx4 v[92:95], v30, s[12:15], s35 offen offset:0 nt
  s_mov_b32 s35, 98304
  buffer_load_dwordx4 v[96:99], v30, s[12:15], s35 offen offset:1024 nt
  s_nop 0
  v_add_f32_dpp v36, v28, v28 row_ror:8 row_mask:0xf bank_mask:0x3
  v_add_f32_dpp v36, v29, v29 row_ror:8 row_mask:0xf bank_mask:0xc
  s_nop 1
  v_add_f32_dpp v36, v36, v36 row_half_mirror row_mask:0xf bank_mask:0xf
  s_nop 1
  v_add_f32_dpp v36, v36, v36 quad_perm:[1,0,3,2] row_mask:0xf bank_mask:0xf
  s_nop 1
  v_add_f32_dpp v36, v36, v36 quad_perm:[2,3,0,1] row_mask:0xf bank_mask:0xf
  v_cndmask_b32 v41, v41, v36, s[50:51]
  s_waitcnt vmcnt(4)
  v_dot2_f32_bf16 v28, v76, v4, 0
  v_dot2_f32_bf16 v29, v80, v4, 0
  v_dot2_f32_bf16 v28, v77, v5, v28
  v_dot2_f32_bf16 v29, v81, v5, v29
  v_dot2_f32_bf16 v28, v78, v6, v28
  v_dot2_f32_bf16 v29, v82, v6, v29
  v_dot2_f32_bf16 v28, v79, v7, v28
  v_dot2_f32_bf16 v29, v83, v7, v29
  s_mov_b32 s35, 106496
  buffer_load_dwordx4 v[100:103], v30, s[12:15], s35 offen offset:0 nt
  s_nop 0
  v_add_f32_dpp v36, v28, v28 row_ror:8 row_mask:0xf bank_mask:0x3
  v_add_f32_dpp v36, v29, v29 row_ror:8 row_mask:0xf bank_mask:0xc
  s_nop 1
  v_add_f32_dpp v36, v36, v36 row_half_mirror row_mask:0xf bank_mask:0xf
  s_nop 1
  v_add_f32_dpp v36, v36, v36 quad_perm:[1,0,3,2] row_mask:0xf bank_mask:0xf
  s_nop 1
  v_add_f32_dpp v36, v36, v36 quad_perm:[2,3,0,1] row_mask:0xf bank_mask:0xf
  v_cndmask_b32 v41, v41, v36, s[52:53]
  s_waitcnt vmcnt(3)
  v_dot2_f32_bf16 v28, v84, v4, 0
  v_dot2_f32_bf16 v29, v88, v4, 0
  v_dot2_f32_bf16 v28, v85, v5, v28
  v_dot2_f32_bf16 v29, v89, v5, v29
  v_dot2_f32_bf16 v28, v86, v6, v28
  v_dot2_f32_bf16 v29, v90, v6, v29
  v_dot2_f32_bf16 v28, v87, v7, v28
  v_dot2_f32_bf16 v29, v91, v7, v29
  s_mov_b32 s35, 106496
  buffer_load_dwordx4 v[104:107], v30, s[12:15], s35 offen offset:1024 nt
  s_mov_b32 s35, 114688
  buffer_load_dwordx4 v[108:111], v30, s[12:15], s35 offen offset:0 nt
  s_mov_b32 s35, 114688
  buffer_load_dwordx4 v[112:115], v30, s[12:15], s35 offen offset:1024 nt
  s_nop 0
  v_add_f32_dpp v36, v28, v28 row_ror:8 row_mask:0xf bank_mask:0x3
  v_add_f32_dpp v36, v29, v29 row_ror:8 row_mask:0xf bank_mask:0xc
  s_nop 1
  v_add_f32_dpp v36, v36, v36 row_half_mirror row_mask:0xf bank_mask:0xf
  s_nop 1
  v_add_f32_dpp v36, v36, v36 quad_perm:[1,0,3,2] row_mask:0xf bank_mask:0xf
  s_nop 1
  v_add_f32_dpp v36, v36, v36 quad_perm:[2,3,0,1] row_mask:0xf bank_mask:0xf
  v_cndmask_b32 v41, v41, v36, s[54:55]
  s_waitcnt vmcnt(4)
  v_dot2_f32_bf16 v28, v92, v4, 0
  v_dot2_f32_bf16 v29, v96, v4, 0
  v_dot2_f32_bf16 v28, v93, v5, v28
  v_dot2_f32_bf16 v29, v97, v5, v29
  v_dot2_f32_bf16 v28, v94, v6, v28
  v_dot2_f32_bf16 v29, v98, v6, v29
  v_dot2_f32_bf16 v28, v95, v7, v28
  v_dot2_f32_bf16 v29, v99, v7, v29
  s_mov_b32 s35, 122880
  buffer_load_dwordx4 v[116:119], v30, s[12:15], s35 offen offset:0 nt
  s_mov_b32 s35, 122880
  buffer_load_dwordx4 v[120:123], v30, s[12:15], s35 offen offset:1024 nt
  s_nop 0
  v_add_f32_dpp v36, v28, v28 row_ror:8 row_mask:0xf bank_mask:0x3
  v_add_f32_dpp v36, v29, v29 row_ror:8 row_mask:0xf bank_mask:0xc
  s_nop 1
  v_add_f32_dpp v36, v36, v36 row_half_mirror row_mask:0xf bank_mask:0xf
  s_nop 1
  v_add_f32_dpp v36, v36, v36 quad_perm:[1,0,3,2] row_mask:0xf bank_mask:0xf
  s_nop 1
  v_add_f32_dpp v36, v36, v36 quad_perm:[2,3,0,1] row_mask:0xf bank_mask:0xf
  v_cndmask_b32 v41, v41, v36, s[56:57]
  s_waitcnt vmcnt(4)
  v_dot2_f32_bf16 v28, v100, v4, 0
  v_dot2_f32_bf16 v29, v104, v4, 0
  v_dot2_f32_bf16 v28, v101, v5, v28
  v_dot2_f32_bf16 v29, v105, v5, v29
  v_dot2_f32_bf16 v28, v102, v6, v28
  v_dot2_f32_bf16 v29, v106, v6, v29
  v_dot2_f32_bf16 v28, v103, v7, v28
  v_dot2_f32_bf16 v29, v107, v7, v29
  s_mov_b32 s35, 131072
  buffer_load_dwordx4 v[60:63], v30, s[12:15], s35 offen offset:0 nt
  s_mov_b32 s35, 131072
  buffer_load_dwordx4 v[64:67], v30, s[12:15], s35 offen offset:1024 nt
  s_nop 0
  v_add_f32_dpp v36, v28, v28 row_ror:8 row_mask:0xf bank_mask:0x3
  v_add_f32_dpp v36, v29, v29 row_ror:8 row_mask:0xf bank_mask:0xc
  s_nop 1
  v_add_f32_dpp v36, v36, v36 row_half_mirror row_mask:0xf bank_mask:0xf
  s_nop 1
  v_add_f32_dpp v36, v36, v36 quad_perm:[1,0,3,2] row_mask:0xf bank_mask:0xf
  s_nop 1
  v_add_f32_dpp v36, v36, v36 quad_perm:[2,3,0,1] row_mask:0xf bank_mask:0xf
  v_cndmask_b32 v41, v41, v36, s[58:59]
  s_waitcnt vmcnt(4)
  v_dot2_f32_bf16 v28, v108, v4, 0
  v_dot2_f32_bf16 v29, v112, v4, 0
  v_dot2_f32_bf16 v28, v109, v5, v28
  v_dot2_f32_bf16 v29, v113, v5, v29
  v_dot2_f32_bf16 v28, v110, v6, v28
  v_dot2_f32_bf16 v29, v114, v6, v29
  v_dot2_f32_bf16 v28, v111, v7, v28
  v_dot2_f32_bf16 v29, v115, v7, v29
  s_mov_b32 s35, 139264
  buffer_load_dwordx4 v[68:71], v30, s[12:15], s35 offen offset:0 nt
  s_mov_b32 s35, 139264
  buffer_load_dwordx4 v[72:75], v30, s[12:15], s35 offen offset:1024 nt
  s_nop 0
  v_add_f32_dpp v36, v28, v28 row_ror:8 row_mask:0xf bank_mask:0x3
  v_add_f32_dpp v36, v29, v29 row_ror:8 row_mask:0xf bank_mask:0xc
  s_nop 1
  v_add_f32_dpp v36, v36, v36 row_half_mirror row_mask:0xf bank_mask:0xf
  s_nop 1
  v_add_f32_dpp v36, v36, v36 quad_perm:[1,0,3,2] row_mask:0xf bank_mask:0xf
  s_nop 1
  v_add_f32_dpp v36, v36, v36 quad_perm:[2,3,0,1] row_mask:0xf bank_mask:0xf
  v_cndmask_b32 v41, v41, v36, s[60:61]
  s_waitcnt vmcnt(4)
  v_dot2_f32_bf16 v28, v116, v4, 0
  v_dot2_f32_bf16 v29, v120, v4, 0
  v_dot2_f32_bf16 v28, v117, v5, v28
  v_dot2_f32_bf16 v29, v121, v5, v29
  v_dot2_f32_bf16 v28, v118, v6, v28
  v_dot2_f32_bf16 v29, v122, v6, v29
  v_dot2_f32_bf16 v28, v119, v7, v28
  v_dot2_f32_bf16 v29, v123, v7, v29
  s_mov_b32 s35, 147456
  buffer_load_dwordx4 v[76:79], v30, s[12:15], s35 offen offset:0 nt
  s_nop 0
  v_add_f32_dpp v36, v28, v28 row_ror:8 row_mask:0xf bank_mask:0x3
  v_add_f32_dpp v36, v29, v29 row_ror:8 row_mask:0xf bank_mask:0xc
  s_nop 1
  v_add_f32_dpp v36, v36, v36 row_half_mirror row_mask:0xf bank_mask:0xf
  s_nop 1
  v_add_f32_dpp v36, v36, v36 quad_perm:[1,0,3,2] row_mask:0xf bank_mask:0xf
  s_nop 1
  v_add_f32_dpp v36, v36, v36 quad_perm:[2,3,0,1] row_mask:0xf bank_mask:0xf
  v_cndmask_b32 v41, v41, v36, s[62:63]
  s_waitcnt vmcnt(3)
  v_dot2_f32_bf16 v28, v60, v4, 0
  v_dot2_f32_bf16 v29, v64, v4, 0
  v_dot2_f32_bf16 v28, v61, v5, v28
  v_dot2_f32_bf16 v29, v65, v5, v29
  v_dot2_f32_bf16 v28, v62, v6, v28
  v_dot2_f32_bf16 v29, v66, v6, v29
  v_dot2_f32_bf16 v28, v63, v7, v28
  v_dot2_f32_bf16 v29, v67, v7, v29
  s_mov_b32 s35, 147456
  buffer_load_dwordx4 v[80:83], v30, s[12:15], s35 offen offset:1024 nt
  s_mov_b32 s35, 155648
  buffer_load_dwordx4 v[84:87], v30, s[12:15], s35 offen offset:0 nt
  s_mov_b32 s35, 155648
  buffer_load_dwordx4 v[88:91], v30, s[12:15], s35 offen offset:1024 nt
  s_nop 0
  v_add_f32_dpp v36, v28, v28 row_ror:8 row_mask:0xf bank_mask:0x3
  v_add_f32_dpp v36, v29, v29 row_ror:8 row_mask:0xf bank_mask:0xc
  s_nop 1
  v_add_f32_dpp v36, v36, v36 row_half_mirror row_mask:0xf bank_mask:0xf
  s_nop 1
  v_add_f32_dpp v36, v36, v36 quad_perm:[1,0,3,2] row_mask:0xf bank_mask:0xf
  s_nop 1
  v_add_f32_dpp v36, v36, v36 quad_perm:[2,3,0,1] row_mask:0xf bank_mask:0xf
  v_cndmask_b32 v42, v42, v36, s[48:49]
  s_waitcnt vmcnt(4)
  v_dot2_f32_bf16 v28, v68, v4, 0
  v_dot2_f32_bf16 v29, v72, v4, 0
  v_dot2_f32_bf16 v28, v69, v5, v28
  v_dot2_f32_bf16 v29, v73, v5, v29
  v_dot2_f32_bf16 v28, v70, v6, v28
  v_dot2_f32_bf16 v29, v74, v6, v29
  v_dot2_f32_bf16 v28, v71, v7, v28
  v_dot2_f32_bf16 v29, v75, v7, v29
  s_mov_b32 s35, 163840
  buffer_load_dwordx4 v[92:95], v30, s[12:15], s35 offen offset:0 nt
  s_mov_b32 s35, 163840
  buffer_load_dwordx4 v[96:99], v30, s[12:15], s35 offen offset:1024 nt
  s_nop 0
  v_add_f32_dpp v36, v28, v28 row_ror:8 row_mask:0xf bank_mask:0x3
  v_add_f32_dpp v36, v29, v29 row_ror:8 row_mask:0xf bank_mask:0xc
  s_nop 1
  v_add_f32_dpp v36, v36, v36 row_half_mirror row_mask:0xf bank_mask:0xf
  s_nop 1
  v_add_f32_dpp v36, v36, v36 quad_perm:[1,0,3,2] row_mask:0xf bank_mask:0xf
  s_nop 1
  v_add_f32_dpp v36, v36, v36 quad_perm:[2,3,0,1] row_mask:0xf bank_mask:0xf
  v_cndmask_b32 v42, v42, v36, s[50:51]
  s_waitcnt vmcnt(4)
  v_dot2_f32_bf16 v28, v76, v4, 0
  v_dot2_f32_bf16 v29, v80, v4, 0
  v_dot2_f32_bf16 v28, v77, v5, v28
  v_dot2_f32_bf16 v29, v81, v5, v29
  v_dot2_f32_bf16 v28, v78, v6, v28
  v_dot2_f32_bf16 v29, v82, v6, v29
  v_dot2_f32_bf16 v28, v79, v7, v28
  v_dot2_f32_bf16 v29, v83, v7, v29
  s_mov_b32 s35, 172032
  buffer_load_dwordx4 v[100:103], v30, s[12:15], s35 offen offset:0 nt
  s_mov_b32 s35, 172032
  buffer_load_dwordx4 v[104:107], v30, s[12:15], s35 offen offset:1024 nt
  s_nop 0
  v_add_f32_dpp v36, v28, v28 row_ror:8 row_mask:0xf bank_mask:0x3
  v_add_f32_dpp v36, v29, v29 row_ror:8 row_mask:0xf bank_mask:0xc
  s_nop 1
  v_add_f32_dpp v36, v36, v36 row_half_mirror row_mask:0xf bank_mask:0xf
  s_nop 1
  v_add_f32_dpp v36, v36, v36 quad_perm:[1,0,3,2] row_mask:0xf bank_mask:0xf
  s_nop 1
  v_add_f32_dpp v36, v36, v36 quad_perm:[2,3,0,1] row_mask:0xf bank_mask:0xf
  v_cndmask_b32 v42, v42, v36, s[52:53]
  s_waitcnt vmcnt(4)
  v_dot2_f32_bf16 v28, v84, v4, 0
  v_dot2_f32_bf16 v29, v88, v4, 0
  v_dot2_f32_bf16 v28, v85, v5, v28
  v_dot2_f32_bf16 v29, v89, v5, v29
  v_dot2_f32_bf16 v28, v86, v6, v28
  v_dot2_f32_bf16 v29, v90, v6, v29
  v_dot2_f32_bf16 v28, v87, v7, v28
  v_dot2_f32_bf16 v29, v91, v7, v29
  s_mov_b32 s35, 180224
  buffer_load_dwordx4 v[108:111], v30, s[12:15], s35 offen offset:0 nt
  s_mov_b32 s35, 180224
  buffer_load_dwordx4 v[112:115], v30, s[12:15], s35 offen offset:1024 nt
  s_nop 0
  v_add_f32_dpp v36, v28, v28 row_ror:8 row_mask:0xf bank_mask:0x3
  v_add_f32_dpp v36, v29, v29 row_ror:8 row_mask:0xf bank_mask:0xc
  s_nop 1
  v_add_f32_dpp v36, v36, v36 row_half_mirror row_mask:0xf bank_mask:0xf
  s_nop 1
  v_add_f32_dpp v36, v36, v36 quad_perm:[1,0,3,2] row_mask:0xf bank_mask:0xf
  s_nop 1
  v_add_f32_dpp v36, v36, v36 quad_perm:[2,3,0,1] row_mask:0xf bank_mask:0xf
  v_cndmask_b32 v42, v42, v36, s[54:55]
  s_waitcnt vmcnt(4)
  v_dot2_f32_bf16 v28, v92, v4, 0
  v_dot2_f32_bf16 v29, v96, v4, 0
  v_dot2_f32_bf16 v28, v93, v5, v28
  v_dot2_f32_bf16 v29, v97, v5, v29
  v_dot2_f32_bf16 v28, v94, v6, v28
  v_dot2_f32_bf16 v29, v98, v6, v29
  v_dot2_f32_bf16 v28, v95, v7, v28
  v_dot2_f32_bf16 v29, v99, v7, v29
  s_mov_b32 s35, 188416
  buffer_load_dwordx4 v[116:119], v30, s[12:15], s35 offen offset:0 nt
  s_nop 0
  v_add_f32_dpp v36, v28, v28 row_ror:8 row_mask:0xf bank_mask:0x3
  v_add_f32_dpp v36, v29, v29 row_ror:8 row_mask:0xf bank_mask:0xc
  s_nop 1
  v_add_f32_dpp v36, v36, v36 row_half_mirror row_mask:0xf bank_mask:0xf
  s_nop 1
  v_add_f32_dpp v36, v36, v36 quad_perm:[1,0,3,2] row_mask:0xf bank_mask:0xf
  s_nop 1
  v_add_f32_dpp v36, v36, v36 quad_perm:[2,3,0,1] row_mask:0xf bank_mask:0xf
  v_cndmask_b32 v42, v42, v36, s[56:57]
  s_waitcnt vmcnt(3)
  v_dot2_f32_bf16 v28, v100, v4, 0
  v_dot2_f32_bf16 v29, v104, v4, 0
  v_dot2_f32_bf16 v28, v101, v5, v28
  v_dot2_f32_bf16 v29, v105, v5, v29
  v_dot2_f32_bf16 v28, v102, v6, v28
  v_dot2_f32_bf16 v29, v106, v6, v29
  v_dot2_f32_bf16 v28, v103, v7, v28
  v_dot2_f32_bf16 v29, v107, v7, v29
  s_mov_b32 s35, 188416
  buffer_load_dwordx4 v[120:123], v30, s[12:15], s35 offen offset:1024 nt
  s_mov_b32 s35, 196608
  buffer_load_dwordx4 v[60:63], v30, s[12:15], s35 offen offset:0 nt
  s_mov_b32 s35, 196608
  buffer_load_dwordx4 v[64:67], v30, s[12:15], s35 offen offset:1024 nt
  s_nop 0
  v_add_f32_dpp v36, v28, v28 row_ror:8 row_mask:0xf bank_mask:0x3
  v_add_f32_dpp v36, v29, v29 row_ror:8 row_mask:0xf bank_mask:0xc
  s_nop 1
  v_add_f32_dpp v36, v36, v36 row_half_mirror row_mask:0xf bank_mask:0xf
  s_nop 1
  v_add_f32_dpp v36, v36, v36 quad_perm:[1,0,3,2] row_mask:0xf bank_mask:0xf
  s_nop 1
  v_add_f32_dpp v36, v36, v36 quad_perm:[2,3,0,1] row_mask:0xf bank_mask:0xf
  v_cndmask_b32 v42, v42, v36, s[58:59]
  s_waitcnt vmcnt(4)
  v_dot2_f32_bf16 v28, v108, v4, 0
  v_dot2_f32_bf16 v29, v112, v4, 0
  v_dot2_f32_bf16 v28, v109, v5, v28
  v_dot2_f32_bf16 v29, v113, v5, v29
  v_dot2_f32_bf16 v28, v110, v6, v28
  v_dot2_f32_bf16 v29, v114, v6, v29
  v_dot2_f32_bf16 v28, v111, v7, v28
  v_dot2_f32_bf16 v29, v115, v7, v29
  s_mov_b32 s35, 204800
  buffer_load_dwordx4 v[68:71], v30, s[12:15], s35 offen offset:0 nt
  s_mov_b32 s35, 204800
  buffer_load_dwordx4 v[72:75], v30, s[12:15], s35 offen offset:1024 nt
  s_nop 0
  v_add_f32_dpp v36, v28, v28 row_ror:8 row_mask:0xf bank_mask:0x3
  v_add_f32_dpp v36, v29, v29 row_ror:8 row_mask:0xf bank_mask:0xc
  s_nop 1
  v_add_f32_dpp v36, v36, v36 row_half_mirror row_mask:0xf bank_mask:0xf
  s_nop 1
  v_add_f32_dpp v36, v36, v36 quad_perm:[1,0,3,2] row_mask:0xf bank_mask:0xf
  s_nop 1
  v_add_f32_dpp v36, v36, v36 quad_perm:[2,3,0,1] row_mask:0xf bank_mask:0xf
  v_cndmask_b32 v42, v42, v36, s[60:61]
  s_waitcnt vmcnt(4)
  v_dot2_f32_bf16 v28, v116, v4, 0
  v_dot2_f32_bf16 v29, v120, v4, 0
  v_dot2_f32_bf16 v28, v117, v5, v28
  v_dot2_f32_bf16 v29, v121, v5, v29
  v_dot2_f32_bf16 v28, v118, v6, v28
  v_dot2_f32_bf16 v29, v122, v6, v29
  v_dot2_f32_bf16 v28, v119, v7, v28
  v_dot2_f32_bf16 v29, v123, v7, v29
  s_mov_b32 s35, 212992
  buffer_load_dwordx4 v[76:79], v30, s[12:15], s35 offen offset:0 nt
  s_mov_b32 s35, 212992
  buffer_load_dwordx4 v[80:83], v30, s[12:15], s35 offen offset:1024 nt
  s_nop 0
  v_add_f32_dpp v36, v28, v28 row_ror:8 row_mask:0xf bank_mask:0x3
  v_add_f32_dpp v36, v29, v29 row_ror:8 row_mask:0xf bank_mask:0xc
  s_nop 1
  v_add_f32_dpp v36, v36, v36 row_half_mirror row_mask:0xf bank_mask:0xf
  s_nop 1
  v_add_f32_dpp v36, v36, v36 quad_perm:[1,0,3,2] row_mask:0xf bank_mask:0xf
  s_nop 1
  v_add_f32_dpp v36, v36, v36 quad_perm:[2,3,0,1] row_mask:0xf bank_mask:0xf
  v_cndmask_b32 v42, v42, v36, s[62:63]
  s_waitcnt vmcnt(4)
  v_dot2_f32_bf16 v28, v60, v4, 0
  v_dot2_f32_bf16 v29, v64, v4, 0
  v_dot2_f32_bf16 v28, v61, v5, v28
  v_dot2_f32_bf16 v29, v65, v5, v29
  v_dot2_f32_bf16 v28, v62, v6, v28
  v_dot2_f32_bf16 v29, v66, v6, v29
  v_dot2_f32_bf16 v28, v63, v7, v28
  v_dot2_f32_bf16 v29, v67, v7, v29
  s_mov_b32 s35, 221184
  buffer_load_dwordx4 v[84:87], v30, s[12:15], s35 offen offset:0 nt
  s_mov_b32 s35, 221184
  buffer_load_dwordx4 v[88:91], v30, s[12:15], s35 offen offset:1024 nt
  s_nop 0
  v_add_f32_dpp v36, v28, v28 row_ror:8 row_mask:0xf bank_mask:0x3
  v_add_f32_dpp v36, v29, v29 row_ror:8 row_mask:0xf bank_mask:0xc
  s_nop 1
  v_add_f32_dpp v36, v36, v36 row_half_mirror row_mask:0xf bank_mask:0xf
  s_nop 1
  v_add_f32_dpp v36, v36, v36 quad_perm:[1,0,3,2] row_mask:0xf bank_mask:0xf
  s_nop 1
  v_add_f32_dpp v36, v36, v36 quad_perm:[2,3,0,1] row_mask:0xf bank_mask:0xf
  v_cndmask_b32 v43, v43, v36, s[48:49]
  s_waitcnt vmcnt(4)
  v_dot2_f32_bf16 v28, v68, v4, 0
  v_dot2_f32_bf16 v29, v72, v4, 0
  v_dot2_f32_bf16 v28, v69, v5, v28
  v_dot2_f32_bf16 v29, v73, v5, v29
  v_dot2_f32_bf16 v28, v70, v6, v28
  v_dot2_f32_bf16 v29, v74, v6, v29
  v_dot2_f32_bf16 v28, v71, v7, v28
  v_dot2_f32_bf16 v29, v75, v7, v29
  s_mov_b32 s35, 229376
  buffer_load_dwordx4 v[92:95], v30, s[12:15], s35 offen offset:0 nt
  s_nop 0
  v_add_f32_dpp v36, v28, v28 row_ror:8 row_mask:0xf bank_mask:0x3
  v_add_f32_dpp v36, v29, v29 row_ror:8 row_mask:0xf bank_mask:0xc
  s_nop 1
  v_add_f32_dpp v36, v36, v36 row_half_mirror row_mask:0xf bank_mask:0xf
  s_nop 1
  v_add_f32_dpp v36, v36, v36 quad_perm:[1,0,3,2] row_mask:0xf bank_mask:0xf
  s_nop 1
  v_add_f32_dpp v36, v36, v36 quad_perm:[2,3,0,1] row_mask:0xf bank_mask:0xf
  v_cndmask_b32 v43, v43, v36, s[50:51]
  s_waitcnt vmcnt(3)
  v_dot2_f32_bf16 v28, v76, v4, 0
  v_dot2_f32_bf16 v29, v80, v4, 0
  v_dot2_f32_bf16 v28, v77, v5, v28
  v_dot2_f32_bf16 v29, v81, v5, v29
  v_dot2_f32_bf16 v28, v78, v6, v28
  v_dot2_f32_bf16 v29, v82, v6, v29
  v_dot2_f32_bf16 v28, v79, v7, v28
  v_dot2_f32_bf16 v29, v83, v7, v29
  s_mov_b32 s35, 229376
  buffer_load_dwordx4 v[96:99], v30, s[12:15], s35 offen offset:1024 nt
  s_mov_b32 s35, 237568
  buffer_load_dwordx4 v[100:103], v30, s[12:15], s35 offen offset:0 nt
  s_mov_b32 s35, 237568
  buffer_load_dwordx4 v[104:107], v30, s[12:15], s35 offen offset:1024 nt
  s_nop 0
  v_add_f32_dpp v36, v28, v28 row_ror:8 row_mask:0xf bank_mask:0x3
  v_add_f32_dpp v36, v29, v29 row_ror:8 row_mask:0xf bank_mask:0xc
  s_nop 1
  v_add_f32_dpp v36, v36, v36 row_half_mirror row_mask:0xf bank_mask:0xf
  s_nop 1
  v_add_f32_dpp v36, v36, v36 quad_perm:[1,0,3,2] row_mask:0xf bank_mask:0xf
  s_nop 1
  v_add_f32_dpp v36, v36, v36 quad_perm:[2,3,0,1] row_mask:0xf bank_mask:0xf
  v_cndmask_b32 v43, v43, v36, s[52:53]
  s_waitcnt vmcnt(4)
  v_dot2_f32_bf16 v28, v84, v4, 0
  v_dot2_f32_bf16 v29, v88, v4, 0
  v_dot2_f32_bf16 v28, v85, v5, v28
  v_dot2_f32_bf16 v29, v89, v5, v29
  v_dot2_f32_bf16 v28, v86, v6, v28
  v_dot2_f32_bf16 v29, v90, v6, v29
  v_dot2_f32_bf16 v28, v87, v7, v28
  v_dot2_f32_bf16 v29, v91, v7, v29
  s_mov_b32 s35, 245760
  buffer_load_dwordx4 v[108:111], v30, s[12:15], s35 offen offset:0 nt
  s_mov_b32 s35, 245760
  buffer_load_dwordx4 v[112:115], v30, s[12:15], s35 offen offset:1024 nt
  s_nop 0
  v_add_f32_dpp v36, v28, v28 row_ror:8 row_mask:0xf bank_mask:0x3
  v_add_f32_dpp v36, v29, v29 row_ror:8 row_mask:0xf bank_mask:0xc
  s_nop 1
  v_add_f32_dpp v36, v36, v36 row_half_mirror row_mask:0xf bank_mask:0xf
  s_nop 1
  v_add_f32_dpp v36, v36, v36 quad_perm:[1,0,3,2] row_mask:0xf bank_mask:0xf
  s_nop 1
  v_add_f32_dpp v36, v36, v36 quad_perm:[2,3,0,1] row_mask:0xf bank_mask:0xf
  v_cndmask_b32 v43, v43, v36, s[54:55]
  s_waitcnt vmcnt(4)
  v_dot2_f32_bf16 v28, v92, v4, 0
  v_dot2_f32_bf16 v29, v96, v4, 0
  v_dot2_f32_bf16 v28, v93, v5, v28
  v_dot2_f32_bf16 v29, v97, v5, v29
  v_dot2_f32_bf16 v28, v94, v6, v28
  v_dot2_f32_bf16 v29, v98, v6, v29
  v_dot2_f32_bf16 v28, v95, v7, v28
  v_dot2_f32_bf16 v29, v99, v7, v29
  s_mov_b32 s35, 253952
  buffer_load_dwordx4 v[116:119], v30, s[12:15], s35 offen offset:0 nt
  s_mov_b32 s35, 253952
  buffer_load_dwordx4 v[120:123], v30, s[12:15], s35 offen offset:1024 nt
  s_nop 0
  v_add_f32_dpp v36, v28, v28 row_ror:8 row_mask:0xf bank_mask:0x3
  v_add_f32_dpp v36, v29, v29 row_ror:8 row_mask:0xf bank_mask:0xc
  s_nop 1
  v_add_f32_dpp v36, v36, v36 row_half_mirror row_mask:0xf bank_mask:0xf
  s_nop 1
  v_add_f32_dpp v36, v36, v36 quad_perm:[1,0,3,2] row_mask:0xf bank_mask:0xf
  s_nop 1
  v_add_f32_dpp v36, v36, v36 quad_perm:[2,3,0,1] row_mask:0xf bank_mask:0xf
  v_cndmask_b32 v43, v43, v36, s[56:57]
  s_waitcnt vmcnt(4)
  v_dot2_f32_bf16 v28, v100, v4, 0
  v_dot2_f32_bf16 v29, v104, v4, 0
  v_dot2_f32_bf16 v28, v101, v5, v28
  v_dot2_f32_bf16 v29, v105, v5, v29
  v_dot2_f32_bf16 v28, v102, v6, v28
  v_dot2_f32_bf16 v29, v106, v6, v29
  v_dot2_f32_bf16 v28, v103, v7, v28
  v_dot2_f32_bf16 v29, v107, v7, v29
  s_mov_b32 s35, 262144
  buffer_load_dwordx4 v[60:63], v30, s[12:15], s35 offen offset:0 nt
  s_mov_b32 s35, 262144
  buffer_load_dwordx4 v[64:67], v30, s[12:15], s35 offen offset:1024 nt
  s_nop 0
  v_add_f32_dpp v36, v28, v28 row_ror:8 row_mask:0xf bank_mask:0x3
  v_add_f32_dpp v36, v29, v29 row_ror:8 row_mask:0xf bank_mask:0xc
  s_nop 1
  v_add_f32_dpp v36, v36, v36 row_half_mirror row_mask:0xf bank_mask:0xf
  s_nop 1
  v_add_f32_dpp v36, v36, v36 quad_perm:[1,0,3,2] row_mask:0xf bank_mask:0xf
  s_nop 1
  v_add_f32_dpp v36, v36, v36 quad_perm:[2,3,0,1] row_mask:0xf bank_mask:0xf
  v_cndmask_b32 v43, v43, v36, s[58:59]
  s_waitcnt vmcnt(4)
  v_dot2_f32_bf16 v28, v108, v4, 0
  v_dot2_f32_bf16 v29, v112, v4, 0
  v_dot2_f32_bf16 v28, v109, v5, v28
  v_dot2_f32_bf16 v29, v113, v5, v29
  v_dot2_f32_bf16 v28, v110, v6, v28
  v_dot2_f32_bf16 v29, v114, v6, v29
  v_dot2_f32_bf16 v28, v111, v7, v28
  v_dot2_f32_bf16 v29, v115, v7, v29
  s_mov_b32 s35, 270336
  buffer_load_dwordx4 v[68:71], v30, s[12:15], s35 offen offset:0 nt
  s_nop 0
  v_add_f32_dpp v36, v28, v28 row_ror:8 row_mask:0xf bank_mask:0x3
  v_add_f32_dpp v36, v29, v29 row_ror:8 row_mask:0xf bank_mask:0xc
  s_nop 1
  v_add_f32_dpp v36, v36, v36 row_half_mirror row_mask:0xf bank_mask:0xf
  s_nop 1
  v_add_f32_dpp v36, v36, v36 quad_perm:[1,0,3,2] row_mask:0xf bank_mask:0xf
  s_nop 1
  v_add_f32_dpp v36, v36, v36 quad_perm:[2,3,0,1] row_mask:0xf bank_mask:0xf
  v_cndmask_b32 v43, v43, v36, s[60:61]
  s_waitcnt vmcnt(3)
  v_dot2_f32_bf16 v28, v116, v4, 0
  v_dot2_f32_bf16 v29, v120, v4, 0
  v_dot2_f32_bf16 v28, v117, v5, v28
  v_dot2_f32_bf16 v29, v121, v5, v29
  v_dot2_f32_bf16 v28, v118, v6, v28
  v_dot2_f32_bf16 v29, v122, v6, v29
  v_dot2_f32_bf16 v28, v119, v7, v28
  v_dot2_f32_bf16 v29, v123, v7, v29
  s_mov_b32 s35, 270336
  buffer_load_dwordx4 v[72:75], v30, s[12:15], s35 offen offset:1024 nt
  s_mov_b32 s35, 278528
  buffer_load_dwordx4 v[76:79], v30, s[12:15], s35 offen offset:0 nt
  s_mov_b32 s35, 278528
  buffer_load_dwordx4 v[80:83], v30, s[12:15], s35 offen offset:1024 nt
  s_nop 0
  v_add_f32_dpp v36, v28, v28 row_ror:8 row_mask:0xf bank_mask:0x3
  v_add_f32_dpp v36, v29, v29 row_ror:8 row_mask:0xf bank_mask:0xc
  s_nop 1
  v_add_f32_dpp v36, v36, v36 row_half_mirror row_mask:0xf bank_mask:0xf
  s_nop 1
  v_add_f32_dpp v36, v36, v36 quad_perm:[1,0,3,2] row_mask:0xf bank_mask:0xf
  s_nop 1
  v_add_f32_dpp v36, v36, v36 quad_perm:[2,3,0,1] row_mask:0xf bank_mask:0xf
  v_cndmask_b32 v43, v43, v36, s[62:63]
  s_waitcnt vmcnt(4)
  v_dot2_f32_bf16 v28, v60, v4, 0
  v_dot2_f32_bf16 v29, v64, v4, 0
  v_dot2_f32_bf16 v28, v61, v5, v28
  v_dot2_f32_bf16 v29, v65, v5, v29
  v_dot2_f32_bf16 v28, v62, v6, v28
  v_dot2_f32_bf16 v29, v66, v6, v29
  v_dot2_f32_bf16 v28, v63, v7, v28
  v_dot2_f32_bf16 v29, v67, v7, v29
  s_mov_b32 s35, 286720
  buffer_load_dwordx4 v[84:87], v30, s[12:15], s35 offen offset:0 nt
  s_mov_b32 s35, 286720
  buffer_load_dwordx4 v[88:91], v30, s[12:15], s35 offen offset:1024 nt
  s_nop 0
  v_add_f32_dpp v36, v28, v28 row_ror:8 row_mask:0xf bank_mask:0x3
  v_add_f32_dpp v36, v29, v29 row_ror:8 row_mask:0xf bank_mask:0xc
  s_nop 1
  v_add_f32_dpp v36, v36, v36 row_half_mirror row_mask:0xf bank_mask:0xf
  s_nop 1
  v_add_f32_dpp v36, v36, v36 quad_perm:[1,0,3,2] row_mask:0xf bank_mask:0xf
  s_nop 1
  v_add_f32_dpp v36, v36, v36 quad_perm:[2,3,0,1] row_mask:0xf bank_mask:0xf
  v_cndmask_b32 v44, v44, v36, s[48:49]
  s_waitcnt vmcnt(4)
  v_dot2_f32_bf16 v28, v68, v4, 0
  v_dot2_f32_bf16 v29, v72, v4, 0
  v_dot2_f32_bf16 v28, v69, v5, v28
  v_dot2_f32_bf16 v29, v73, v5, v29
  v_dot2_f32_bf16 v28, v70, v6, v28
  v_dot2_f32_bf16 v29, v74, v6, v29
  v_dot2_f32_bf16 v28, v71, v7, v28
  v_dot2_f32_bf16 v29, v75, v7, v29
  s_mov_b32 s35, 294912
  buffer_load_dwordx4 v[92:95], v30, s[12:15], s35 offen offset:0 nt
  s_mov_b32 s35, 294912
  buffer_load_dwordx4 v[96:99], v30, s[12:15], s35 offen offset:1024 nt
  s_nop 0
  v_add_f32_dpp v36, v28, v28 row_ror:8 row_mask:0xf bank_mask:0x3
  v_add_f32_dpp v36, v29, v29 row_ror:8 row_mask:0xf bank_mask:0xc
  s_nop 1
  v_add_f32_dpp v36, v36, v36 row_half_mirror row_mask:0xf bank_mask:0xf
  s_nop 1
  v_add_f32_dpp v36, v36, v36 quad_perm:[1,0,3,2] row_mask:0xf bank_mask:0xf
  s_nop 1
  v_add_f32_dpp v36, v36, v36 quad_perm:[2,3,0,1] row_mask:0xf bank_mask:0xf
  v_cndmask_b32 v44, v44, v36, s[50:51]
  s_waitcnt vmcnt(4)
  v_dot2_f32_bf16 v28, v76, v4, 0
  v_dot2_f32_bf16 v29, v80, v4, 0
  v_dot2_f32_bf16 v28, v77, v5, v28
  v_dot2_f32_bf16 v29, v81, v5, v29
  v_dot2_f32_bf16 v28, v78, v6, v28
  v_dot2_f32_bf16 v29, v82, v6, v29
  v_dot2_f32_bf16 v28, v79, v7, v28
  v_dot2_f32_bf16 v29, v83, v7, v29
  s_mov_b32 s35, 303104
  buffer_load_dwordx4 v[100:103], v30, s[12:15], s35 offen offset:0 nt
  s_mov_b32 s35, 303104
  buffer_load_dwordx4 v[104:107], v30, s[12:15], s35 offen offset:1024 nt
  s_nop 0
  v_add_f32_dpp v36, v28, v28 row_ror:8 row_mask:0xf bank_mask:0x3
  v_add_f32_dpp v36, v29, v29 row_ror:8 row_mask:0xf bank_mask:0xc
  s_nop 1
  v_add_f32_dpp v36, v36, v36 row_half_mirror row_mask:0xf bank_mask:0xf
  s_nop 1
  v_add_f32_dpp v36, v36, v36 quad_perm:[1,0,3,2] row_mask:0xf bank_mask:0xf
  s_nop 1
  v_add_f32_dpp v36, v36, v36 quad_perm:[2,3,0,1] row_mask:0xf bank_mask:0xf
  v_cndmask_b32 v44, v44, v36, s[52:53]
  s_waitcnt vmcnt(4)
  v_dot2_f32_bf16 v28, v84, v4, 0
  v_dot2_f32_bf16 v29, v88, v4, 0
  v_dot2_f32_bf16 v28, v85, v5, v28
  v_dot2_f32_bf16 v29, v89, v5, v29
  v_dot2_f32_bf16 v28, v86, v6, v28
  v_dot2_f32_bf16 v29, v90, v6, v29
  v_dot2_f32_bf16 v28, v87, v7, v28
  v_dot2_f32_bf16 v29, v91, v7, v29
  s_mov_b32 s35, 311296
  buffer_load_dwordx4 v[108:111], v30, s[12:15], s35 offen offset:0 nt
  s_nop 0
  v_add_f32_dpp v36, v28, v28 row_ror:8 row_mask:0xf bank_mask:0x3
  v_add_f32_dpp v36, v29, v29 row_ror:8 row_mask:0xf bank_mask:0xc
  s_nop 1
  v_add_f32_dpp v36, v36, v36 row_half_mirror row_mask:0xf bank_mask:0xf
  s_nop 1
  v_add_f32_dpp v36, v36, v36 quad_perm:[1,0,3,2] row_mask:0xf bank_mask:0xf
  s_nop 1
  v_add_f32_dpp v36, v36, v36 quad_perm:[2,3,0,1] row_mask:0xf bank_mask:0xf
  v_cndmask_b32 v44, v44, v36, s[54:55]
  s_waitcnt vmcnt(3)
  v_dot2_f32_bf16 v28, v92, v4, 0
  v_dot2_f32_bf16 v29, v96, v4, 0
  v_dot2_f32_bf16 v28, v93, v5, v28
  v_dot2_f32_bf16 v29, v97, v5, v29
  v_dot2_f32_bf16 v28, v94, v6, v28
  v_dot2_f32_bf16 v29, v98, v6, v29
  v_dot2_f32_bf16 v28, v95, v7, v28
  v_dot2_f32_bf16 v29, v99, v7, v29
  s_mov_b32 s35, 311296
  buffer_load_dwordx4 v[112:115], v30, s[12:15], s35 offen offset:1024 nt
  s_mov_b32 s35, 319488
  buffer_load_dwordx4 v[116:119], v30, s[12:15], s35 offen offset:0 nt
  s_mov_b32 s35, 319488
  buffer_load_dwordx4 v[120:123], v30, s[12:15], s35 offen offset:1024 nt
  s_nop 0
  v_add_f32_dpp v36, v28, v28 row_ror:8 row_mask:0xf bank_mask:0x3
  v_add_f32_dpp v36, v29, v29 row_ror:8 row_mask:0xf bank_mask:0xc
  s_nop 1
  v_add_f32_dpp v36, v36, v36 row_half_mirror row_mask:0xf bank_mask:0xf
  s_nop 1
  v_add_f32_dpp v36, v36, v36 quad_perm:[1,0,3,2] row_mask:0xf bank_mask:0xf
  s_nop 1
  v_add_f32_dpp v36, v36, v36 quad_perm:[2,3,0,1] row_mask:0xf bank_mask:0xf
  v_cndmask_b32 v44, v44, v36, s[56:57]
  s_waitcnt vmcnt(4)
  v_dot2_f32_bf16 v28, v100, v4, 0
  v_dot2_f32_bf16 v29, v104, v4, 0
  v_dot2_f32_bf16 v28, v101, v5, v28
  v_dot2_f32_bf16 v29, v105, v5, v29
  v_dot2_f32_bf16 v28, v102, v6, v28
  v_dot2_f32_bf16 v29, v106, v6, v29
  v_dot2_f32_bf16 v28, v103, v7, v28
  v_dot2_f32_bf16 v29, v107, v7, v29
  s_mov_b32 s35, 327680
  buffer_load_dwordx4 v[60:63], v30, s[12:15], s35 offen offset:0 nt
  s_mov_b32 s35, 327680
  buffer_load_dwordx4 v[64:67], v30, s[12:15], s35 offen offset:1024 nt
  s_nop 0
  v_add_f32_dpp v36, v28, v28 row_ror:8 row_mask:0xf bank_mask:0x3
  v_add_f32_dpp v36, v29, v29 row_ror:8 row_mask:0xf bank_mask:0xc
  s_nop 1
  v_add_f32_dpp v36, v36, v36 row_half_mirror row_mask:0xf bank_mask:0xf
  s_nop 1
  v_add_f32_dpp v36, v36, v36 quad_perm:[1,0,3,2] row_mask:0xf bank_mask:0xf
  s_nop 1
  v_add_f32_dpp v36, v36, v36 quad_perm:[2,3,0,1] row_mask:0xf bank_mask:0xf
  v_cndmask_b32 v44, v44, v36, s[58:59]
  s_waitcnt vmcnt(4)
  v_dot2_f32_bf16 v28, v108, v4, 0
  v_dot2_f32_bf16 v29, v112, v4, 0
  v_dot2_f32_bf16 v28, v109, v5, v28
  v_dot2_f32_bf16 v29, v113, v5, v29
  v_dot2_f32_bf16 v28, v110, v6, v28
  v_dot2_f32_bf16 v29, v114, v6, v29
  v_dot2_f32_bf16 v28, v111, v7, v28
  v_dot2_f32_bf16 v29, v115, v7, v29
  s_mov_b32 s35, 335872
  buffer_load_dwordx4 v[68:71], v30, s[12:15], s35 offen offset:0 nt
  s_mov_b32 s35, 335872
  buffer_load_dwordx4 v[72:75], v30, s[12:15], s35 offen offset:1024 nt
  s_nop 0
  v_add_f32_dpp v36, v28, v28 row_ror:8 row_mask:0xf bank_mask:0x3
  v_add_f32_dpp v36, v29, v29 row_ror:8 row_mask:0xf bank_mask:0xc
  s_nop 1
  v_add_f32_dpp v36, v36, v36 row_half_mirror row_mask:0xf bank_mask:0xf
  s_nop 1
  v_add_f32_dpp v36, v36, v36 quad_perm:[1,0,3,2] row_mask:0xf bank_mask:0xf
  s_nop 1
  v_add_f32_dpp v36, v36, v36 quad_perm:[2,3,0,1] row_mask:0xf bank_mask:0xf
  v_cndmask_b32 v44, v44, v36, s[60:61]
  s_waitcnt vmcnt(4)
  v_dot2_f32_bf16 v28, v116, v4, 0
  v_dot2_f32_bf16 v29, v120, v4, 0
  v_dot2_f32_bf16 v28, v117, v5, v28
  v_dot2_f32_bf16 v29, v121, v5, v29
  v_dot2_f32_bf16 v28, v118, v6, v28
  v_dot2_f32_bf16 v29, v122, v6, v29
  v_dot2_f32_bf16 v28, v119, v7, v28
  v_dot2_f32_bf16 v29, v123, v7, v29
  s_mov_b32 s35, 344064
  buffer_load_dwordx4 v[76:79], v30, s[12:15], s35 offen offset:0 nt
  s_mov_b32 s35, 344064
  buffer_load_dwordx4 v[80:83], v30, s[12:15], s35 offen offset:1024 nt
  s_nop 0
  v_add_f32_dpp v36, v28, v28 row_ror:8 row_mask:0xf bank_mask:0x3
  v_add_f32_dpp v36, v29, v29 row_ror:8 row_mask:0xf bank_mask:0xc
  s_nop 1
  v_add_f32_dpp v36, v36, v36 row_half_mirror row_mask:0xf bank_mask:0xf
  s_nop 1
  v_add_f32_dpp v36, v36, v36 quad_perm:[1,0,3,2] row_mask:0xf bank_mask:0xf
  s_nop 1
  v_add_f32_dpp v36, v36, v36 quad_perm:[2,3,0,1] row_mask:0xf bank_mask:0xf
  v_cndmask_b32 v44, v44, v36, s[62:63]
  s_waitcnt vmcnt(4)
  v_dot2_f32_bf16 v28, v60, v4, 0
  v_dot2_f32_bf16 v29, v64, v4, 0
  v_dot2_f32_bf16 v28, v61, v5, v28
  v_dot2_f32_bf16 v29, v65, v5, v29
  v_dot2_f32_bf16 v28, v62, v6, v28
  v_dot2_f32_bf16 v29, v66, v6, v29
  v_dot2_f32_bf16 v28, v63, v7, v28
  v_dot2_f32_bf16 v29, v67, v7, v29
  s_mov_b32 s35, 352256
  buffer_load_dwordx4 v[84:87], v30, s[12:15], s35 offen offset:0 nt
  s_nop 0
  v_add_f32_dpp v36, v28, v28 row_ror:8 row_mask:0xf bank_mask:0x3
  v_add_f32_dpp v36, v29, v29 row_ror:8 row_mask:0xf bank_mask:0xc
  s_nop 1
  v_add_f32_dpp v36, v36, v36 row_half_mirror row_mask:0xf bank_mask:0xf
  s_nop 1
  v_add_f32_dpp v36, v36, v36 quad_perm:[1,0,3,2] row_mask:0xf bank_mask:0xf
  s_nop 1
  v_add_f32_dpp v36, v36, v36 quad_perm:[2,3,0,1] row_mask:0xf bank_mask:0xf
  v_cndmask_b32 v45, v45, v36, s[48:49]
  s_waitcnt vmcnt(3)
  v_dot2_f32_bf16 v28, v68, v4, 0
  v_dot2_f32_bf16 v29, v72, v4, 0
  v_dot2_f32_bf16 v28, v69, v5, v28
  v_dot2_f32_bf16 v29, v73, v5, v29
  v_dot2_f32_bf16 v28, v70, v6, v28
  v_dot2_f32_bf16 v29, v74, v6, v29
  v_dot2_f32_bf16 v28, v71, v7, v28
  v_dot2_f32_bf16 v29, v75, v7, v29
  s_mov_b32 s35, 352256
  buffer_load_dwordx4 v[88:91], v30, s[12:15], s35 offen offset:1024 nt
  s_mov_b32 s35, 360448
  buffer_load_dwordx4 v[92:95], v30, s[12:15], s35 offen offset:0 nt
  s_mov_b32 s35, 360448
  buffer_load_dwordx4 v[96:99], v30, s[12:15], s35 offen offset:1024 nt
  s_nop 0
  v_add_f32_dpp v36, v28, v28 row_ror:8 row_mask:0xf bank_mask:0x3
  v_add_f32_dpp v36, v29, v29 row_ror:8 row_mask:0xf bank_mask:0xc
  s_nop 1
  v_add_f32_dpp v36, v36, v36 row_half_mirror row_mask:0xf bank_mask:0xf
  s_nop 1
  v_add_f32_dpp v36, v36, v36 quad_perm:[1,0,3,2] row_mask:0xf bank_mask:0xf
  s_nop 1
  v_add_f32_dpp v36, v36, v36 quad_perm:[2,3,0,1] row_mask:0xf bank_mask:0xf
  v_cndmask_b32 v45, v45, v36, s[50:51]
  s_waitcnt vmcnt(4)
  v_dot2_f32_bf16 v28, v76, v4, 0
  v_dot2_f32_bf16 v29, v80, v4, 0
  v_dot2_f32_bf16 v28, v77, v5, v28
  v_dot2_f32_bf16 v29, v81, v5, v29
  v_dot2_f32_bf16 v28, v78, v6, v28
  v_dot2_f32_bf16 v29, v82, v6, v29
  v_dot2_f32_bf16 v28, v79, v7, v28
  v_dot2_f32_bf16 v29, v83, v7, v29
  s_mov_b32 s35, 368640
  buffer_load_dwordx4 v[100:103], v30, s[12:15], s35 offen offset:0 nt
  s_mov_b32 s35, 368640
  buffer_load_dwordx4 v[104:107], v30, s[12:15], s35 offen offset:1024 nt
  s_nop 0
  v_add_f32_dpp v36, v28, v28 row_ror:8 row_mask:0xf bank_mask:0x3
  v_add_f32_dpp v36, v29, v29 row_ror:8 row_mask:0xf bank_mask:0xc
  s_nop 1
  v_add_f32_dpp v36, v36, v36 row_half_mirror row_mask:0xf bank_mask:0xf
  s_nop 1
  v_add_f32_dpp v36, v36, v36 quad_perm:[1,0,3,2] row_mask:0xf bank_mask:0xf
  s_nop 1
  v_add_f32_dpp v36, v36, v36 quad_perm:[2,3,0,1] row_mask:0xf bank_mask:0xf
  v_cndmask_b32 v45, v45, v36, s[52:53]
  s_waitcnt vmcnt(4)
  v_dot2_f32_bf16 v28, v84, v4, 0
  v_dot2_f32_bf16 v29, v88, v4, 0
  v_dot2_f32_bf16 v28, v85, v5, v28
  v_dot2_f32_bf16 v29, v89, v5, v29
  v_dot2_f32_bf16 v28, v86, v6, v28
  v_dot2_f32_bf16 v29, v90, v6, v29
  v_dot2_f32_bf16 v28, v87, v7, v28
  v_dot2_f32_bf16 v29, v91, v7, v29
  s_mov_b32 s35, 376832
  buffer_load_dwordx4 v[108:111], v30, s[12:15], s35 offen offset:0 nt
  s_mov_b32 s35, 376832
  buffer_load_dwordx4 v[112:115], v30, s[12:15], s35 offen offset:1024 nt
  s_nop 0
  v_add_f32_dpp v36, v28, v28 row_ror:8 row_mask:0xf bank_mask:0x3
  v_add_f32_dpp v36, v29, v29 row_ror:8 row_mask:0xf bank_mask:0xc
  s_nop 1
  v_add_f32_dpp v36, v36, v36 row_half_mirror row_mask:0xf bank_mask:0xf
  s_nop 1
  v_add_f32_dpp v36, v36, v36 quad_perm:[1,0,3,2] row_mask:0xf bank_mask:0xf
  s_nop 1
  v_add_f32_dpp v36, v36, v36 quad_perm:[2,3,0,1] row_mask:0xf bank_mask:0xf
  v_cndmask_b32 v45, v45, v36, s[54:55]
  s_waitcnt vmcnt(4)
  v_dot2_f32_bf16 v28, v92, v4, 0
  v_dot2_f32_bf16 v29, v96, v4, 0
  v_dot2_f32_bf16 v28, v93, v5, v28
  v_dot2_f32_bf16 v29, v97, v5, v29
  v_dot2_f32_bf16 v28, v94, v6, v28
  v_dot2_f32_bf16 v29, v98, v6, v29
  v_dot2_f32_bf16 v28, v95, v7, v28
  v_dot2_f32_bf16 v29, v99, v7, v29
  s_mov_b32 s35, 385024
  buffer_load_dwordx4 v[116:119], v30, s[12:15], s35 offen offset:0 nt
  s_mov_b32 s35, 385024
  buffer_load_dwordx4 v[120:123], v30, s[12:15], s35 offen offset:1024 nt
  s_nop 0
  v_add_f32_dpp v36, v28, v28 row_ror:8 row_mask:0xf bank_mask:0x3
  v_add_f32_dpp v36, v29, v29 row_ror:8 row_mask:0xf bank_mask:0xc
  s_nop 1
  v_add_f32_dpp v36, v36, v36 row_half_mirror row_mask:0xf bank_mask:0xf
  s_nop 1
  v_add_f32_dpp v36, v36, v36 quad_perm:[1,0,3,2] row_mask:0xf bank_mask:0xf
  s_nop 1
  v_add_f32_dpp v36, v36, v36 quad_perm:[2,3,0,1] row_mask:0xf bank_mask:0xf
  v_cndmask_b32 v45, v45, v36, s[56:57]
  s_waitcnt vmcnt(4)
  v_dot2_f32_bf16 v28, v100, v4, 0
  v_dot2_f32_bf16 v29, v104, v4, 0
  v_dot2_f32_bf16 v28, v101, v5, v28
  v_dot2_f32_bf16 v29, v105, v5, v29
  v_dot2_f32_bf16 v28, v102, v6, v28
  v_dot2_f32_bf16 v29, v106, v6, v29
  v_dot2_f32_bf16 v28, v103, v7, v28
  v_dot2_f32_bf16 v29, v107, v7, v29
  s_mov_b32 s35, 393216
  buffer_load_dwordx4 v[60:63], v30, s[12:15], s35 offen offset:0 nt
  s_nop 0
  v_add_f32_dpp v36, v28, v28 row_ror:8 row_mask:0xf bank_mask:0x3
  v_add_f32_dpp v36, v29, v29 row_ror:8 row_mask:0xf bank_mask:0xc
  s_nop 1
  v_add_f32_dpp v36, v36, v36 row_half_mirror row_mask:0xf bank_mask:0xf
  s_nop 1
  v_add_f32_dpp v36, v36, v36 quad_perm:[1,0,3,2] row_mask:0xf bank_mask:0xf
  s_nop 1
  v_add_f32_dpp v36, v36, v36 quad_perm:[2,3,0,1] row_mask:0xf bank_mask:0xf
  v_cndmask_b32 v45, v45, v36, s[58:59]
  s_waitcnt vmcnt(3)
  v_dot2_f32_bf16 v28, v108, v4, 0
  v_dot2_f32_bf16 v29, v112, v4, 0
  v_dot2_f32_bf16 v28, v109, v5, v28
  v_dot2_f32_bf16 v29, v113, v5, v29
  v_dot2_f32_bf16 v28, v110, v6, v28
  v_dot2_f32_bf16 v29, v114, v6, v29
  v_dot2_f32_bf16 v28, v111, v7, v28
  v_dot2_f32_bf16 v29, v115, v7, v29
  s_mov_b32 s35, 393216
  buffer_load_dwordx4 v[64:67], v30, s[12:15], s35 offen offset:1024 nt
  s_mov_b32 s35, 401408
  buffer_load_dwordx4 v[68:71], v30, s[12:15], s35 offen offset:0 nt
  s_mov_b32 s35, 401408
  buffer_load_dwordx4 v[72:75], v30, s[12:15], s35 offen offset:1024 nt
  s_nop 0
  v_add_f32_dpp v36, v28, v28 row_ror:8 row_mask:0xf bank_mask:0x3
  v_add_f32_dpp v36, v29, v29 row_ror:8 row_mask:0xf bank_mask:0xc
  s_nop 1
  v_add_f32_dpp v36, v36, v36 row_half_mirror row_mask:0xf bank_mask:0xf
  s_nop 1
  v_add_f32_dpp v36, v36, v36 quad_perm:[1,0,3,2] row_mask:0xf bank_mask:0xf
  s_nop 1
  v_add_f32_dpp v36, v36, v36 quad_perm:[2,3,0,1] row_mask:0xf bank_mask:0xf
  v_cndmask_b32 v45, v45, v36, s[60:61]
  s_waitcnt vmcnt(4)
  v_dot2_f32_bf16 v28, v116, v4, 0
  v_dot2_f32_bf16 v29, v120, v4, 0
  v_dot2_f32_bf16 v28, v117, v5, v28
  v_dot2_f32_bf16 v29, v121, v5, v29
  v_dot2_f32_bf16 v28, v118, v6, v28
  v_dot2_f32_bf16 v29, v122, v6, v29
  v_dot2_f32_bf16 v28, v119, v7, v28
  v_dot2_f32_bf16 v29, v123, v7, v29
  s_mov_b32 s35, 409600
  buffer_load_dwordx4 v[76:79], v30, s[12:15], s35 offen offset:0 nt
  s_mov_b32 s35, 409600
  buffer_load_dwordx4 v[80:83], v30, s[12:15], s35 offen offset:1024 nt
  s_nop 0
  v_add_f32_dpp v36, v28, v28 row_ror:8 row_mask:0xf bank_mask:0x3
  v_add_f32_dpp v36, v29, v29 row_ror:8 row_mask:0xf bank_mask:0xc
  s_nop 1
  v_add_f32_dpp v36, v36, v36 row_half_mirror row_mask:0xf bank_mask:0xf
  s_nop 1
  v_add_f32_dpp v36, v36, v36 quad_perm:[1,0,3,2] row_mask:0xf bank_mask:0xf
  s_nop 1
  v_add_f32_dpp v36, v36, v36 quad_perm:[2,3,0,1] row_mask:0xf bank_mask:0xf
  v_cndmask_b32 v45, v45, v36, s[62:63]
  s_waitcnt vmcnt(4)
  v_dot2_f32_bf16 v28, v60, v4, 0
  v_dot2_f32_bf16 v29, v64, v4, 0
  v_dot2_f32_bf16 v28, v61, v5, v28
  v_dot2_f32_bf16 v29, v65, v5, v29
  v_dot2_f32_bf16 v28, v62, v6, v28
  v_dot2_f32_bf16 v29, v66, v6, v29
  v_dot2_f32_bf16 v28, v63, v7, v28
  v_dot2_f32_bf16 v29, v67, v7, v29
  s_mov_b32 s35, 417792
  buffer_load_dwordx4 v[84:87], v30, s[12:15], s35 offen offset:0 nt
  s_mov_b32 s35, 417792
  buffer_load_dwordx4 v[88:91], v30, s[12:15], s35 offen offset:1024 nt
  s_nop 0
  v_add_f32_dpp v36, v28, v28 row_ror:8 row_mask:0xf bank_mask:0x3
  v_add_f32_dpp v36, v29, v29 row_ror:8 row_mask:0xf bank_mask:0xc
  s_nop 1
  v_add_f32_dpp v36, v36, v36 row_half_mirror row_mask:0xf bank_mask:0xf
  s_nop 1
  v_add_f32_dpp v36, v36, v36 quad_perm:[1,0,3,2] row_mask:0xf bank_mask:0xf
  s_nop 1
  v_add_f32_dpp v36, v36, v36 quad_perm:[2,3,0,1] row_mask:0xf bank_mask:0xf
  v_cndmask_b32 v46, v46, v36, s[48:49]
  s_waitcnt vmcnt(4)
  v_dot2_f32_bf16 v28, v68, v4, 0
  v_dot2_f32_bf16 v29, v72, v4, 0
  v_dot2_f32_bf16 v28, v69, v5, v28
  v_dot2_f32_bf16 v29, v73, v5, v29
  v_dot2_f32_bf16 v28, v70, v6, v28
  v_dot2_f32_bf16 v29, v74, v6, v29
  v_dot2_f32_bf16 v28, v71, v7, v28
  v_dot2_f32_bf16 v29, v75, v7, v29
  s_mov_b32 s35, 425984
  buffer_load_dwordx4 v[92:95], v30, s[12:15], s35 offen offset:0 nt
  s_mov_b32 s35, 425984
  buffer_load_dwordx4 v[96:99], v30, s[12:15], s35 offen offset:1024 nt
  s_nop 0
  v_add_f32_dpp v36, v28, v28 row_ror:8 row_mask:0xf bank_mask:0x3
  v_add_f32_dpp v36, v29, v29 row_ror:8 row_mask:0xf bank_mask:0xc
  s_nop 1
  v_add_f32_dpp v36, v36, v36 row_half_mirror row_mask:0xf bank_mask:0xf
  s_nop 1
  v_add_f32_dpp v36, v36, v36 quad_perm:[1,0,3,2] row_mask:0xf bank_mask:0xf
  s_nop 1
  v_add_f32_dpp v36, v36, v36 quad_perm:[2,3,0,1] row_mask:0xf bank_mask:0xf
  v_cndmask_b32 v46, v46, v36, s[50:51]
  s_waitcnt vmcnt(4)
  v_dot2_f32_bf16 v28, v76, v4, 0
  v_dot2_f32_bf16 v29, v80, v4, 0
  v_dot2_f32_bf16 v28, v77, v5, v28
  v_dot2_f32_bf16 v29, v81, v5, v29
  v_dot2_f32_bf16 v28, v78, v6, v28
  v_dot2_f32_bf16 v29, v82, v6, v29
  v_dot2_f32_bf16 v28, v79, v7, v28
  v_dot2_f32_bf16 v29, v83, v7, v29
  s_mov_b32 s35, 434176
  buffer_load_dwordx4 v[100:103], v30, s[12:15], s35 offen offset:0 nt
  s_nop 0
  v_add_f32_dpp v36, v28, v28 row_ror:8 row_mask:0xf bank_mask:0x3
  v_add_f32_dpp v36, v29, v29 row_ror:8 row_mask:0xf bank_mask:0xc
  s_nop 1
  v_add_f32_dpp v36, v36, v36 row_half_mirror row_mask:0xf bank_mask:0xf
  s_nop 1
  v_add_f32_dpp v36, v36, v36 quad_perm:[1,0,3,2] row_mask:0xf bank_mask:0xf
  s_nop 1
  v_add_f32_dpp v36, v36, v36 quad_perm:[2,3,0,1] row_mask:0xf bank_mask:0xf
  v_cndmask_b32 v46, v46, v36, s[52:53]
  s_waitcnt vmcnt(3)
  v_dot2_f32_bf16 v28, v84, v4, 0
  v_dot2_f32_bf16 v29, v88, v4, 0
  v_dot2_f32_bf16 v28, v85, v5, v28
  v_dot2_f32_bf16 v29, v89, v5, v29
  v_dot2_f32_bf16 v28, v86, v6, v28
  v_dot2_f32_bf16 v29, v90, v6, v29
  v_dot2_f32_bf16 v28, v87, v7, v28
  v_dot2_f32_bf16 v29, v91, v7, v29
  s_mov_b32 s35, 434176
  buffer_load_dwordx4 v[104:107], v30, s[12:15], s35 offen offset:1024 nt
  s_mov_b32 s35, 442368
  buffer_load_dwordx4 v[108:111], v30, s[12:15], s35 offen offset:0 nt
  s_mov_b32 s35, 442368
  buffer_load_dwordx4 v[112:115], v30, s[12:15], s35 offen offset:1024 nt
  s_nop 0
  v_add_f32_dpp v36, v28, v28 row_ror:8 row_mask:0xf bank_mask:0x3
  v_add_f32_dpp v36, v29, v29 row_ror:8 row_mask:0xf bank_mask:0xc
  s_nop 1
  v_add_f32_dpp v36, v36, v36 row_half_mirror row_mask:0xf bank_mask:0xf
  s_nop 1
  v_add_f32_dpp v36, v36, v36 quad_perm:[1,0,3,2] row_mask:0xf bank_mask:0xf
  s_nop 1
  v_add_f32_dpp v36, v36, v36 quad_perm:[2,3,0,1] row_mask:0xf bank_mask:0xf
  v_cndmask_b32 v46, v46, v36, s[54:55]
  s_waitcnt vmcnt(4)
  v_dot2_f32_bf16 v28, v92, v4, 0
  v_dot2_f32_bf16 v29, v96, v4, 0
  v_dot2_f32_bf16 v28, v93, v5, v28
  v_dot2_f32_bf16 v29, v97, v5, v29
  v_dot2_f32_bf16 v28, v94, v6, v28
  v_dot2_f32_bf16 v29, v98, v6, v29
  v_dot2_f32_bf16 v28, v95, v7, v28
  v_dot2_f32_bf16 v29, v99, v7, v29
  s_mov_b32 s35, 450560
  buffer_load_dwordx4 v[116:119], v30, s[12:15], s35 offen offset:0 nt
  s_mov_b32 s35, 450560
  buffer_load_dwordx4 v[120:123], v30, s[12:15], s35 offen offset:1024 nt
  s_nop 0
  v_add_f32_dpp v36, v28, v28 row_ror:8 row_mask:0xf bank_mask:0x3
  v_add_f32_dpp v36, v29, v29 row_ror:8 row_mask:0xf bank_mask:0xc
  s_nop 1
  v_add_f32_dpp v36, v36, v36 row_half_mirror row_mask:0xf bank_mask:0xf
  s_nop 1
  v_add_f32_dpp v36, v36, v36 quad_perm:[1,0,3,2] row_mask:0xf bank_mask:0xf
  s_nop 1
  v_add_f32_dpp v36, v36, v36 quad_perm:[2,3,0,1] row_mask:0xf bank_mask:0xf
  v_cndmask_b32 v46, v46, v36, s[56:57]
  s_waitcnt vmcnt(4)
  v_dot2_f32_bf16 v28, v100, v4, 0
  v_dot2_f32_bf16 v29, v104, v4, 0
  v_dot2_f32_bf16 v28, v101, v5, v28
  v_dot2_f32_bf16 v29, v105, v5, v29
  v_dot2_f32_bf16 v28, v102, v6, v28
  v_dot2_f32_bf16 v29, v106, v6, v29
  v_dot2_f32_bf16 v28, v103, v7, v28
  v_dot2_f32_bf16 v29, v107, v7, v29
  s_mov_b32 s35, 458752
  buffer_load_dwordx4 v[60:63], v30, s[12:15], s35 offen offset:0 nt
  s_mov_b32 s35, 458752
  buffer_load_dwordx4 v[64:67], v30, s[12:15], s35 offen offset:1024 nt
  s_nop 0
  v_add_f32_dpp v36, v28, v28 row_ror:8 row_mask:0xf bank_mask:0x3
  v_add_f32_dpp v36, v29, v29 row_ror:8 row_mask:0xf bank_mask:0xc
  s_nop 1
  v_add_f32_dpp v36, v36, v36 row_half_mirror row_mask:0xf bank_mask:0xf
  s_nop 1
  v_add_f32_dpp v36, v36, v36 quad_perm:[1,0,3,2] row_mask:0xf bank_mask:0xf
  s_nop 1
  v_add_f32_dpp v36, v36, v36 quad_perm:[2,3,0,1] row_mask:0xf bank_mask:0xf
  v_cndmask_b32 v46, v46, v36, s[58:59]
  s_waitcnt vmcnt(4)
  v_dot2_f32_bf16 v28, v108, v4, 0
  v_dot2_f32_bf16 v29, v112, v4, 0
  v_dot2_f32_bf16 v28, v109, v5, v28
  v_dot2_f32_bf16 v29, v113, v5, v29
  v_dot2_f32_bf16 v28, v110, v6, v28
  v_dot2_f32_bf16 v29, v114, v6, v29
  v_dot2_f32_bf16 v28, v111, v7, v28
  v_dot2_f32_bf16 v29, v115, v7, v29
  s_mov_b32 s35, 466944
  buffer_load_dwordx4 v[68:71], v30, s[12:15], s35 offen offset:0 nt
  s_mov_b32 s35, 466944
  buffer_load_dwordx4 v[72:75], v30, s[12:15], s35 offen offset:1024 nt
  s_nop 0
  v_add_f32_dpp v36, v28, v28 row_ror:8 row_mask:0xf bank_mask:0x3
  v_add_f32_dpp v36, v29, v29 row_ror:8 row_mask:0xf bank_mask:0xc
  s_nop 1
  v_add_f32_dpp v36, v36, v36 row_half_mirror row_mask:0xf bank_mask:0xf
  s_nop 1
  v_add_f32_dpp v36, v36, v36 quad_perm:[1,0,3,2] row_mask:0xf bank_mask:0xf
  s_nop 1
  v_add_f32_dpp v36, v36, v36 quad_perm:[2,3,0,1] row_mask:0xf bank_mask:0xf
  v_cndmask_b32 v46, v46, v36, s[60:61]
  s_waitcnt vmcnt(4)
  v_dot2_f32_bf16 v28, v116, v4, 0
  v_dot2_f32_bf16 v29, v120, v4, 0
  v_dot2_f32_bf16 v28, v117, v5, v28
  v_dot2_f32_bf16 v29, v121, v5, v29
  v_dot2_f32_bf16 v28, v118, v6, v28
  v_dot2_f32_bf16 v29, v122, v6, v29
  v_dot2_f32_bf16 v28, v119, v7, v28
  v_dot2_f32_bf16 v29, v123, v7, v29
  s_mov_b32 s35, 475136
  buffer_load_dwordx4 v[76:79], v30, s[12:15], s35 offen offset:0 nt
  s_nop 0
  v_add_f32_dpp v36, v28, v28 row_ror:8 row_mask:0xf bank_mask:0x3
  v_add_f32_dpp v36, v29, v29 row_ror:8 row_mask:0xf bank_mask:0xc
  s_nop 1
  v_add_f32_dpp v36, v36, v36 row_half_mirror row_mask:0xf bank_mask:0xf
  s_nop 1
  v_add_f32_dpp v36, v36, v36 quad_perm:[1,0,3,2] row_mask:0xf bank_mask:0xf
  s_nop 1
  v_add_f32_dpp v36, v36, v36 quad_perm:[2,3,0,1] row_mask:0xf bank_mask:0xf
  v_cndmask_b32 v46, v46, v36, s[62:63]
  s_waitcnt vmcnt(3)
  v_dot2_f32_bf16 v28, v60, v4, 0
  v_dot2_f32_bf16 v29, v64, v4, 0
  v_dot2_f32_bf16 v28, v61, v5, v28
  v_dot2_f32_bf16 v29, v65, v5, v29
  v_dot2_f32_bf16 v28, v62, v6, v28
  v_dot2_f32_bf16 v29, v66, v6, v29
  v_dot2_f32_bf16 v28, v63, v7, v28
  v_dot2_f32_bf16 v29, v67, v7, v29
  s_mov_b32 s35, 475136
  buffer_load_dwordx4 v[80:83], v30, s[12:15], s35 offen offset:1024 nt
  s_mov_b32 s35, 483328
  buffer_load_dwordx4 v[84:87], v30, s[12:15], s35 offen offset:0 nt
  s_mov_b32 s35, 483328
  buffer_load_dwordx4 v[88:91], v30, s[12:15], s35 offen offset:1024 nt
  s_nop 0
  v_add_f32_dpp v36, v28, v28 row_ror:8 row_mask:0xf bank_mask:0x3
  v_add_f32_dpp v36, v29, v29 row_ror:8 row_mask:0xf bank_mask:0xc
  s_nop 1
  v_add_f32_dpp v36, v36, v36 row_half_mirror row_mask:0xf bank_mask:0xf
  s_nop 1
  v_add_f32_dpp v36, v36, v36 quad_perm:[1,0,3,2] row_mask:0xf bank_mask:0xf
  s_nop 1
  v_add_f32_dpp v36, v36, v36 quad_perm:[2,3,0,1] row_mask:0xf bank_mask:0xf
  v_cndmask_b32 v47, v47, v36, s[48:49]
  s_waitcnt vmcnt(4)
  v_dot2_f32_bf16 v28, v68, v4, 0
  v_dot2_f32_bf16 v29, v72, v4, 0
  v_dot2_f32_bf16 v28, v69, v5, v28
  v_dot2_f32_bf16 v29, v73, v5, v29
  v_dot2_f32_bf16 v28, v70, v6, v28
  v_dot2_f32_bf16 v29, v74, v6, v29
  v_dot2_f32_bf16 v28, v71, v7, v28
  v_dot2_f32_bf16 v29, v75, v7, v29
  s_mov_b32 s35, 491520
  buffer_load_dwordx4 v[92:95], v30, s[12:15], s35 offen offset:0 nt
  s_mov_b32 s35, 491520
  buffer_load_dwordx4 v[96:99], v30, s[12:15], s35 offen offset:1024 nt
  s_nop 0
  v_add_f32_dpp v36, v28, v28 row_ror:8 row_mask:0xf bank_mask:0x3
  v_add_f32_dpp v36, v29, v29 row_ror:8 row_mask:0xf bank_mask:0xc
  s_nop 1
  v_add_f32_dpp v36, v36, v36 row_half_mirror row_mask:0xf bank_mask:0xf
  s_nop 1
  v_add_f32_dpp v36, v36, v36 quad_perm:[1,0,3,2] row_mask:0xf bank_mask:0xf
  s_nop 1
  v_add_f32_dpp v36, v36, v36 quad_perm:[2,3,0,1] row_mask:0xf bank_mask:0xf
  v_cndmask_b32 v47, v47, v36, s[50:51]
  s_waitcnt vmcnt(4)
  v_dot2_f32_bf16 v28, v76, v4, 0
  v_dot2_f32_bf16 v29, v80, v4, 0
  v_dot2_f32_bf16 v28, v77, v5, v28
  v_dot2_f32_bf16 v29, v81, v5, v29
  v_dot2_f32_bf16 v28, v78, v6, v28
  v_dot2_f32_bf16 v29, v82, v6, v29
  v_dot2_f32_bf16 v28, v79, v7, v28
  v_dot2_f32_bf16 v29, v83, v7, v29
  s_mov_b32 s35, 499712
  buffer_load_dwordx4 v[100:103], v30, s[12:15], s35 offen offset:0 nt
  s_mov_b32 s35, 499712
  buffer_load_dwordx4 v[104:107], v30, s[12:15], s35 offen offset:1024 nt
  s_nop 0
  v_add_f32_dpp v36, v28, v28 row_ror:8 row_mask:0xf bank_mask:0x3
  v_add_f32_dpp v36, v29, v29 row_ror:8 row_mask:0xf bank_mask:0xc
  s_nop 1
  v_add_f32_dpp v36, v36, v36 row_half_mirror row_mask:0xf bank_mask:0xf
  s_nop 1
  v_add_f32_dpp v36, v36, v36 quad_perm:[1,0,3,2] row_mask:0xf bank_mask:0xf
  s_nop 1
  v_add_f32_dpp v36, v36, v36 quad_perm:[2,3,0,1] row_mask:0xf bank_mask:0xf
  v_cndmask_b32 v47, v47, v36, s[52:53]
  s_waitcnt vmcnt(4)
  v_dot2_f32_bf16 v28, v84, v4, 0
  v_dot2_f32_bf16 v29, v88, v4, 0
  v_dot2_f32_bf16 v28, v85, v5, v28
  v_dot2_f32_bf16 v29, v89, v5, v29
  v_dot2_f32_bf16 v28, v86, v6, v28
  v_dot2_f32_bf16 v29, v90, v6, v29
  v_dot2_f32_bf16 v28, v87, v7, v28
  v_dot2_f32_bf16 v29, v91, v7, v29
  s_mov_b32 s35, 507904
  buffer_load_dwordx4 v[108:111], v30, s[12:15], s35 offen offset:0 nt
  s_mov_b32 s35, 507904
  buffer_load_dwordx4 v[112:115], v30, s[12:15], s35 offen offset:1024 nt
  s_nop 0
  v_add_f32_dpp v36, v28, v28 row_ror:8 row_mask:0xf bank_mask:0x3
  v_add_f32_dpp v36, v29, v29 row_ror:8 row_mask:0xf bank_mask:0xc
  s_nop 1
  v_add_f32_dpp v36, v36, v36 row_half_mirror row_mask:0xf bank_mask:0xf
  s_nop 1
  v_add_f32_dpp v36, v36, v36 quad_perm:[1,0,3,2] row_mask:0xf bank_mask:0xf
  s_nop 1
  v_add_f32_dpp v36, v36, v36 quad_perm:[2,3,0,1] row_mask:0xf bank_mask:0xf
  v_cndmask_b32 v47, v47, v36, s[54:55]
  s_waitcnt vmcnt(4)
  v_dot2_f32_bf16 v28, v92, v4, 0
  v_dot2_f32_bf16 v29, v96, v4, 0
  v_dot2_f32_bf16 v28, v93, v5, v28
  v_dot2_f32_bf16 v29, v97, v5, v29
  v_dot2_f32_bf16 v28, v94, v6, v28
  v_dot2_f32_bf16 v29, v98, v6, v29
  v_dot2_f32_bf16 v28, v95, v7, v28
  v_dot2_f32_bf16 v29, v99, v7, v29
  s_mov_b32 s35, 516096
  buffer_load_dwordx4 v[116:119], v30, s[12:15], s35 offen offset:0 nt
  s_nop 0
  v_add_f32_dpp v36, v28, v28 row_ror:8 row_mask:0xf bank_mask:0x3
  v_add_f32_dpp v36, v29, v29 row_ror:8 row_mask:0xf bank_mask:0xc
  s_nop 1
  v_add_f32_dpp v36, v36, v36 row_half_mirror row_mask:0xf bank_mask:0xf
  s_nop 1
  v_add_f32_dpp v36, v36, v36 quad_perm:[1,0,3,2] row_mask:0xf bank_mask:0xf
  s_nop 1
  v_add_f32_dpp v36, v36, v36 quad_perm:[2,3,0,1] row_mask:0xf bank_mask:0xf
  v_cndmask_b32 v47, v47, v36, s[56:57]
  s_waitcnt vmcnt(3)
  v_dot2_f32_bf16 v28, v100, v4, 0
  v_dot2_f32_bf16 v29, v104, v4, 0
  v_dot2_f32_bf16 v28, v101, v5, v28
  v_dot2_f32_bf16 v29, v105, v5, v29
  v_dot2_f32_bf16 v28, v102, v6, v28
  v_dot2_f32_bf16 v29, v106, v6, v29
  v_dot2_f32_bf16 v28, v103, v7, v28
  v_dot2_f32_bf16 v29, v107, v7, v29
  s_mov_b32 s35, 516096
  buffer_load_dwordx4 v[120:123], v30, s[12:15], s35 offen offset:1024 nt
  buffer_load_dwordx4 v[60:63], v30, s[16:19], 0 offen offset:0 nt
  buffer_load_dwordx4 v[64:67], v30, s[16:19], 0 offen offset:1024 nt
  s_nop 0
  v_add_f32_dpp v36, v28, v28 row_ror:8 row_mask:0xf bank_mask:0x3
  v_add_f32_dpp v36, v29, v29 row_ror:8 row_mask:0xf bank_mask:0xc
  s_nop 1
  v_add_f32_dpp v36, v36, v36 row_half_mirror row_mask:0xf bank_mask:0xf
  s_nop 1
  v_add_f32_dpp v36, v36, v36 quad_perm:[1,0,3,2] row_mask:0xf bank_mask:0xf
  s_nop 1
  v_add_f32_dpp v36, v36, v36 quad_perm:[2,3,0,1] row_mask:0xf bank_mask:0xf
  v_cndmask_b32 v47, v47, v36, s[58:59]
  s_waitcnt vmcnt(4)
  v_dot2_f32_bf16 v28, v108, v4, 0
  v_dot2_f32_bf16 v29, v112, v4, 0
  v_dot2_f32_bf16 v28, v109, v5, v28
  v_dot2_f32_bf16 v29, v113, v5, v29
  v_dot2_f32_bf16 v28, v110, v6, v28
  v_dot2_f32_bf16 v29, v114, v6, v29
  v_dot2_f32_bf16 v28, v111, v7, v28
  v_dot2_f32_bf16 v29, v115, v7, v29
  s_mov_b32 s35, 8192
  buffer_load_dwordx4 v[68:71], v30, s[16:19], s35 offen offset:0 nt
  s_mov_b32 s35, 8192
  buffer_load_dwordx4 v[72:75], v30, s[16:19], s35 offen offset:1024 nt
  s_nop 0
  v_add_f32_dpp v36, v28, v28 row_ror:8 row_mask:0xf bank_mask:0x3
  v_add_f32_dpp v36, v29, v29 row_ror:8 row_mask:0xf bank_mask:0xc
  s_nop 1
  v_add_f32_dpp v36, v36, v36 row_half_mirror row_mask:0xf bank_mask:0xf
  s_nop 1
  v_add_f32_dpp v36, v36, v36 quad_perm:[1,0,3,2] row_mask:0xf bank_mask:0xf
  s_nop 1
  v_add_f32_dpp v36, v36, v36 quad_perm:[2,3,0,1] row_mask:0xf bank_mask:0xf
  v_cndmask_b32 v47, v47, v36, s[60:61]
  s_waitcnt vmcnt(4)
  v_dot2_f32_bf16 v28, v116, v4, 0
  v_dot2_f32_bf16 v29, v120, v4, 0
  v_dot2_f32_bf16 v28, v117, v5, v28
  v_dot2_f32_bf16 v29, v121, v5, v29
  v_dot2_f32_bf16 v28, v118, v6, v28
  v_dot2_f32_bf16 v29, v122, v6, v29
  v_dot2_f32_bf16 v28, v119, v7, v28
  v_dot2_f32_bf16 v29, v123, v7, v29
  s_mov_b32 s35, 16384
  buffer_load_dwordx4 v[76:79], v30, s[16:19], s35 offen offset:0 nt
  s_mov_b32 s35, 16384
  buffer_load_dwordx4 v[80:83], v30, s[16:19], s35 offen offset:1024 nt
  s_nop 0
  v_add_f32_dpp v36, v28, v28 row_ror:8 row_mask:0xf bank_mask:0x3
  v_add_f32_dpp v36, v29, v29 row_ror:8 row_mask:0xf bank_mask:0xc
  s_nop 1
  v_add_f32_dpp v36, v36, v36 row_half_mirror row_mask:0xf bank_mask:0xf
  s_nop 1
  v_add_f32_dpp v36, v36, v36 quad_perm:[1,0,3,2] row_mask:0xf bank_mask:0xf
  s_nop 1
  v_add_f32_dpp v36, v36, v36 quad_perm:[2,3,0,1] row_mask:0xf bank_mask:0xf
  v_cndmask_b32 v47, v47, v36, s[62:63]
  v_max_f32 v24, v40, v41
  v_max_f32 v24, v24, v42
  v_max_f32 v24, v24, v43
  v_max_f32 v24, v24, v44
  v_max_f32 v24, v24, v45
  v_max_f32 v24, v24, v46
  v_max_f32 v24, v24, v47
  s_nop 1
  v_max_f32_dpp v24, v24, v24 quad_perm:[1,0,3,2] row_mask:0xf bank_mask:0xf
  s_nop 1
  v_max_f32_dpp v24, v24, v24 quad_perm:[2,3,0,1] row_mask:0xf bank_mask:0xf
  s_nop 1
  v_max_f32_dpp v24, v24, v24 row_half_mirror row_mask:0xf bank_mask:0xf
  s_nop 1
  v_max_f32_dpp v24, v24, v24 row_mirror row_mask:0xf bank_mask:0xf
  s_nop 1
  v_readlane_b32 s36, v24, 0
  v_readlane_b32 s37, v24, 16
  v_readlane_b32 s38, v24, 32
  v_readlane_b32 s39, v24, 48
  s_nop 1
  v_max_f32 v24, s36, v24
  v_max_f32 v24, s37, v24
  v_max_f32 v24, s38, v24
  v_max_f32 v24, s39, v24
  v_mul_f32 v26, s34, v24
  v_fma_f32 v40, v40, s34, -v26
  v_fma_f32 v41, v41, s34, -v26
  v_fma_f32 v42, v42, s34, -v26
  v_fma_f32 v43, v43, s34, -v26
  v_fma_f32 v44, v44, s34, -v26
  v_fma_f32 v45, v45, s34, -v26
  v_fma_f32 v46, v46, s34, -v26
  v_fma_f32 v47, v47, s34, -v26
  v_exp_f32 v40, v40
  v_exp_f32 v41, v41
  v_exp_f32 v42, v42
  v_exp_f32 v43, v43
  v_exp_f32 v44, v44
  v_exp_f32 v45, v45
  v_exp_f32 v46, v46
  v_exp_f32 v47, v47
  s_nop 0
  v_add_f32 v27, v40, v41
  v_add_f32 v27, v27, v42
  v_add_f32 v27, v27, v43
  v_add_f32 v27, v27, v44
  v_add_f32 v27, v27, v45
  v_add_f32 v27, v27, v46
  v_add_f32 v27, v27, v47
  v_cvt_pk_bf16_f32 v40, v40, v40
  v_cvt_pk_bf16_f32 v41, v41, v41
  v_cvt_pk_bf16_f32 v42, v42, v42
  v_cvt_pk_bf16_f32 v43, v43, v43
  v_cvt_pk_bf16_f32 v44, v44, v44
  v_cvt_pk_bf16_f32 v45, v45, v45
  v_cvt_pk_bf16_f32 v46, v46, v46
  v_cvt_pk_bf16_f32 v47, v47, v47
  v_add_f32_dpp v27, v27, v27 quad_perm:[1,0,3,2] row_mask:0xf bank_mask:0xf
  s_nop 1
  v_add_f32_dpp v27, v27, v27 quad_perm:[2,3,0,1] row_mask:0xf bank_mask:0xf
  s_nop 1
  v_add_f32_dpp v27, v27, v27 row_half_mirror row_mask:0xf bank_mask:0xf
  s_nop 1
  v_add_f32_dpp v27, v27, v27 row_mirror row_mask:0xf bank_mask:0xf
  s_nop 1
  ds_write_b128 v37, v[40:43] offset:0
  ds_write_b128 v37, v[44:47] offset:1024
  v_readlane_b32 s36, v27, 0
  v_readlane_b32 s37, v27, 16
  v_readlane_b32 s38, v27, 32
  v_readlane_b32 s39, v27, 48
  v_lshrrev_b32 v3, 6, v0
  v_lshlrev_b32 v3, 3, v3
  v_mov_b32 v27, s36
  v_add_f32 v27, s37, v27
  v_add_f32 v27, s38, v27
  v_add_f32 v27, s39, v27
  v_add_u32 v3, s40, v3
  v_add_u32 v37, 8192, v37
  ds_write_b64 v3, v[26:27] offset:4096
  s_add_u32 s40, s40, 4224
  s_mov_b32 s12, s16
  s_mov_b32 s13, s17
  s_add_u32 s32, s32, 1
  s_add_u32 s35, s32, 1
  s_cmp_ge_u32 s35, 4
  s_cselect_b32 s16, s22, s20
  s_cselect_b32 s17, s23, s21
  s_and_b32 s43, s35, 3
  s_mul_i32 s43, s43, 134217728
  s_add_u32 s16, s16, s43
  s_addc_u32 s17, s17, 0
  s_cmp_ge_u32 s35, 8
  s_cselect_b32 s18, 0, s42
  s_cmp_lt_u32 s32, 4
  s_waitcnt lgkmcnt(0)
  s_cbranch_scc1 L_khead
  s_mov_b32 s40, 0
  v_subrev_u32 v37, 32768, v37
L_vhead:
  ds_read_b128 v[40:43], v37 offset:0
  ds_read_b128 v[44:47], v37 offset:1024
  v_add_u32 v37, 8192, v37
  s_waitcnt lgkmcnt(0)
  v_mov_b32_dpp v25, v40 row_newbcast:0 row_mask:0xf bank_mask:0x3
  v_mov_b32_dpp v25, v40 row_newbcast:8 row_mask:0xf bank_mask:0xc
  v_and_b32 v20, v25, v8
  v_and_b32 v21, v25, v9
  v_and_b32 v22, v25, v10
  v_and_b32 v23, v25, v11
  s_waitcnt vmcnt(4)
  s_nop 0
  v_mfma_f32_16x16x32_bf16 v[12:15], v[20:23], v[60:63], 0
  v_mfma_f32_16x16x32_bf16 v[16:19], v[20:23], v[64:67], 0
  s_mov_b32 s35, 24576
  buffer_load_dwordx4 v[84:87], v30, s[12:15], s35 offen offset:0 nt
  v_mov_b32_dpp v25, v40 row_newbcast:1 row_mask:0xf bank_mask:0x3
  v_mov_b32_dpp v25, v40 row_newbcast:9 row_mask:0xf bank_mask:0xc
  v_and_b32 v20, v25, v8
  v_and_b32 v21, v25, v9
  v_and_b32 v22, v25, v10
  v_and_b32 v23, v25, v11
  s_waitcnt vmcnt(3)
  s_nop 0
  v_mfma_f32_16x16x32_bf16 v[12:15], v[20:23], v[68:71], v[12:15]
  v_mfma_f32_16x16x32_bf16 v[16:19], v[20:23], v[72:75], v[16:19]
  s_mov_b32 s35, 24576
  buffer_load_dwordx4 v[88:91], v30, s[12:15], s35 offen offset:1024 nt
  s_mov_b32 s35, 32768
  buffer_load_dwordx4 v[92:95], v30, s[12:15], s35 offen offset:0 nt
  s_mov_b32 s35, 32768
  buffer_load_dwordx4 v[96:99], v30, s[12:15], s35 offen offset:1024 nt
  v_mov_b32_dpp v25, v40 row_newbcast:2 row_mask:0xf bank_mask:0x3
  v_mov_b32_dpp v25, v40 row_newbcast:10 row_mask:0xf bank_mask:0xc
  v_and_b32 v20, v25, v8
  v_and_b32 v21, v25, v9
  v_and_b32 v22, v25, v10
  v_and_b32 v23, v25, v11
  s_waitcnt vmcnt(4)
  s_nop 0
  v_mfma_f32_16x16x32_bf16 v[12:15], v[20:23], v[76:79], v[12:15]
  v_mfma_f32_16x16x32_bf16 v[16:19], v[20:23], v[80:83], v[16:19]
  s_mov_b32 s35, 40960
  buffer_load_dwordx4 v[100:103], v30, s[12:15], s35 offen offset:0 nt
  s_mov_b32 s35, 40960
  buffer_load_dwordx4 v[104:107], v30, s[12:15], s35 offen offset:1024 nt
  v_mov_b32_dpp v25, v40 row_newbcast:3 row_mask:0xf bank_mask:0x3
  v_mov_b32_dpp v25, v40 row_newbcast:11 row_mask:0xf bank_mask:0xc
  v_and_b32 v20, v25, v8
  v_and_b32 v21, v25, v9
  v_and_b32 v22, v25, v10
  v_and_b32 v23, v25, v11
  s_waitcnt vmcnt(4)
  s_nop 0
  v_mfma_f32_16x16x32_bf16 v[12:15], v[20:23], v[84:87], v[12:15]
  v_mfma_f32_16x16x32_bf16 v[16:19], v[20:23], v[88:91], v[16:19]
  s_mov_b32 s35, 49152
  buffer_load_dwordx4 v[108:111], v30, s[12:15], s35 offen offset:0 nt
  s_mov_b32 s35, 49152
  buffer_load_dwordx4 v[112:115], v30, s[12:15], s35 offen offset:1024 nt
  v_mov_b32_dpp v25, v40 row_newbcast:4 row_mask:0xf bank_mask:0x3
  v_mov_b32_dpp v25, v40 row_newbcast:12 row_mask:0xf bank_mask:0xc
  v_and_b32 v20, v25, v8
  v_and_b32 v21, v25, v9
  v_and_b32 v22, v25, v10
  v_and_b32 v23, v25, v11
  s_waitcnt vmcnt(4)
  s_nop 0
  v_mfma_f32_16x16x32_bf16 v[12:15], v[20:23], v[92:95], v[12:15]
  v_mfma_f32_16x16x32_bf16 v[16:19], v[20:23], v[96:99], v[16:19]
  s_mov_b32 s35, 57344
  buffer_load_dwordx4 v[116:119], v30, s[12:15], s35 offen offset:0 nt
  s_mov_b32 s35, 57344
  buffer_load_dwordx4 v[120:123], v30, s[12:15], s35 offen offset:1024 nt
  v_mov_b32_dpp v25, v40 row_newbcast:5 row_mask:0xf bank_mask:0x3
  v_mov_b32_dpp v25, v40 row_newbcast:13 row_mask:0xf bank_mask:0xc
  v_and_b32 v20, v25, v8
  v_and_b32 v21, v25, v9
  v_and_b32 v22, v25, v10
  v_and_b32 v23, v25, v11
  s_waitcnt vmcnt(4)
  s_nop 0
  v_mfma_f32_16x16x32_bf16 v[12:15], v[20:23], v[100:103], v[12:15]
  v_mfma_f32_16x16x32_bf16 v[16:19], v[20:23], v[104:107], v[16:19]
  s_mov_b32 s35, 65536
  buffer_load_dwordx4 v[60:63], v30, s[12:15], s35 offen offset:0 nt
  v_mov_b32_dpp v25, v40 row_newbcast:6 row_mask:0xf bank_mask:0x3
  v_mov_b32_dpp v25, v40 row_newbcast:14 row_mask:0xf bank_mask:0xc
  v_and_b32 v20, v25, v8
  v_and_b32 v21, v25, v9
  v_and_b32 v22, v25, v10
  v_and_b32 v23, v25, v11
  s_waitcnt vmcnt(3)
  s_nop 0
  v_mfma_f32_16x16x32_bf16 v[12:15], v[20:23], v[108:111], v[12:15]
  v_mfma_f32_16x16x32_bf16 v[16:19], v[20:23], v[112:115], v[16:19]
  s_mov_b32 s35, 65536
  buffer_load_dwordx4 v[64:67], v30, s[12:15], s35 offen offset:1024 nt
  s_mov_b32 s35, 73728
  buffer_load_dwordx4 v[68:71], v30, s[12:15], s35 offen offset:0 nt
  s_mov_b32 s35, 73728
  buffer_load_dwordx4 v[72:75], v30, s[12:15], s35 offen offset:1024 nt
  v_mov_b32_dpp v25, v40 row_newbcast:7 row_mask:0xf bank_mask:0x3
  v_mov_b32_dpp v25, v40 row_newbcast:15 row_mask:0xf bank_mask:0xc
  v_and_b32 v20, v25, v8
  v_and_b32 v21, v25, v9
  v_and_b32 v22, v25, v10
  v_and_b32 v23, v25, v11
  s_waitcnt vmcnt(4)
  s_nop 0
  v_mfma_f32_16x16x32_bf16 v[12:15], v[20:23], v[116:119], v[12:15]
  v_mfma_f32_16x16x32_bf16 v[16:19], v[20:23], v[120:123], v[16:19]
  s_mov_b32 s35, 81920
  buffer_load_dwordx4 v[76:79], v30, s[12:15], s35 offen offset:0 nt
  s_mov_b32 s35, 81920
  buffer_load_dwordx4 v[80:83], v30, s[12:15], s35 offen offset:1024 nt
  v_mov_b32_dpp v25, v41 row_newbcast:0 row_mask:0xf bank_mask:0x3
  v_mov_b32_dpp v25, v41 row_newbcast:8 row_mask:0xf bank_mask:0xc
  v_and_b32 v20, v25, v8
  v_and_b32 v21, v25, v9
  v_and_b32 v22, v25, v10
  v_and_b32 v23, v25, v11
  s_waitcnt vmcnt(4)
  s_nop 0
  v_mfma_f32_16x16x32_bf16 v[12:15], v[20:23], v[60:63], v[12:15]
  v_mfma_f32_16x16x32_bf16 v[16:19], v[20:23], v[64:67], v[16:19]
  s_mov_b32 s35, 90112
  buffer_load_dwordx4 v[84:87], v30, s[12:15], s35 offen offset:0 nt
  s_mov_b32 s35, 90112
  buffer_load_dwordx4 v[88:91], v30, s[12:15], s35 offen offset:1024 nt
  v_mov_b32_dpp v25, v41 row_newbcast:1 row_mask:0xf bank_mask:0x3
  v_mov_b32_dpp v25, v41 row_newbcast:9 row_mask:0xf bank_mask:0xc
  v_and_b32 v20, v25, v8
  v_and_b32 v21, v25, v9
  v_and_b32 v22, v25, v10
  v_and_b32 v23, v25, v11
  s_waitcnt vmcnt(4)
  s_nop 0
  v_mfma_f32_16x16x32_bf16 v[12:15], v[20:23], v[68:71], v[12:15]
  v_mfma_f32_16x16x32_bf16 v[16:19], v[20:23], v[72:75], v[16:19]
  s_mov_b32 s35, 98304
  buffer_load_dwordx4 v[92:95], v30, s[12:15], s35 offen offset:0 nt
  s_mov_b32 s35, 98304
  buffer_load_dwordx4 v[96:99], v30, s[12:15], s35 offen offset:1024 nt
  v_mov_b32_dpp v25, v41 row_newbcast:2 row_mask:0xf bank_mask:0x3
  v_mov_b32_dpp v25, v41 row_newbcast:10 row_mask:0xf bank_mask:0xc
  v_and_b32 v20, v25, v8
  v_and_b32 v21, v25, v9
  v_and_b32 v22, v25, v10
  v_and_b32 v23, v25, v11
  s_waitcnt vmcnt(4)
  s_nop 0
  v_mfma_f32_16x16x32_bf16 v[12:15], v[20:23], v[76:79], v[12:15]
  v_mfma_f32_16x16x32_bf16 v[16:19], v[20:23], v[80:83], v[16:19]
  s_mov_b32 s35, 106496
  buffer_load_dwordx4 v[100:103], v30, s[12:15], s35 offen offset:0 nt
  v_mov_b32_dpp v25, v41 row_newbcast:3 row_mask:0xf bank_mask:0x3
  v_mov_b32_dpp v25, v41 row_newbcast:11 row_mask:0xf bank_mask:0xc
  v_and_b32 v20, v25, v8
  v_and_b32 v21, v25, v9
  v_and_b32 v22, v25, v10
  v_and_b32 v23, v25, v11
  s_waitcnt vmcnt(3)
  s_nop 0
  v_mfma_f32_16x16x32_bf16 v[12:15], v[20:23], v[84:87], v[12:15]
  v_mfma_f32_16x16x32_bf16 v[16:19], v[20:23], v[88:91], v[16:19]
  s_mov_b32 s35, 106496
  buffer_load_dwordx4 v[104:107], v30, s[12:15], s35 offen offset:1024 nt
  s_mov_b32 s35, 114688
  buffer_load_dwordx4 v[108:111], v30, s[12:15], s35 offen offset:0 nt
  s_mov_b32 s35, 114688
  buffer_load_dwordx4 v[112:115], v30, s[12:15], s35 offen offset:1024 nt
  v_mov_b32_dpp v25, v41 row_newbcast:4 row_mask:0xf bank_mask:0x3
  v_mov_b32_dpp v25, v41 row_newbcast:12 row_mask:0xf bank_mask:0xc
  v_and_b32 v20, v25, v8
  v_and_b32 v21, v25, v9
  v_and_b32 v22, v25, v10
  v_and_b32 v23, v25, v11
  s_waitcnt vmcnt(4)
  s_nop 0
  v_mfma_f32_16x16x32_bf16 v[12:15], v[20:23], v[92:95], v[12:15]
  v_mfma_f32_16x16x32_bf16 v[16:19], v[20:23], v[96:99], v[16:19]
  s_mov_b32 s35, 122880
  buffer_load_dwordx4 v[116:119], v30, s[12:15], s35 offen offset:0 nt
  s_mov_b32 s35, 122880
  buffer_load_dwordx4 v[120:123], v30, s[12:15], s35 offen offset:1024 nt
  v_mov_b32_dpp v25, v41 row_newbcast:5 row_mask:0xf bank_mask:0x3
  v_mov_b32_dpp v25, v41 row_newbcast:13 row_mask:0xf bank_mask:0xc
  v_and_b32 v20, v25, v8
  v_and_b32 v21, v25, v9
  v_and_b32 v22, v25, v10
  v_and_b32 v23, v25, v11
  s_waitcnt vmcnt(4)
  s_nop 0
  v_mfma_f32_16x16x32_bf16 v[12:15], v[20:23], v[100:103], v[12:15]
  v_mfma_f32_16x16x32_bf16 v[16:19], v[20:23], v[104:107], v[16:19]
  s_mov_b32 s35, 131072
  buffer_load_dwordx4 v[60:63], v30, s[12:15], s35 offen offset:0 nt
  s_mov_b32 s35, 131072
  buffer_load_dwordx4 v[64:67], v30, s[12:15], s35 offen offset:1024 nt
  v_mov_b32_dpp v25, v41 row_newbcast:6 row_mask:0xf bank_mask:0x3
  v_mov_b32_dpp v25, v41 row_newbcast:14 row_mask:0xf bank_mask:0xc
  v_and_b32 v20, v25, v8
  v_and_b32 v21, v25, v9
  v_and_b32 v22, v25, v10
  v_and_b32 v23, v25, v11
  s_waitcnt vmcnt(4)
  s_nop 0
  v_mfma_f32_16x16x32_bf16 v[12:15], v[20:23], v[108:111], v[12:15]
  v_mfma_f32_16x16x32_bf16 v[16:19], v[20:23], v[112:115], v[16:19]
  s_mov_b32 s35, 139264
  buffer_load_dwordx4 v[68:71], v30, s[12:15], s35 offen offset:0 nt
  s_mov_b32 s35, 139264
  buffer_load_dwordx4 v[72:75], v30, s[12:15], s35 offen offset:1024 nt
  v_mov_b32_dpp v25, v41 row_newbcast:7 row_mask:0xf bank_mask:0x3
  v_mov_b32_dpp v25, v41 row_newbcast:15 row_mask:0xf bank_mask:0xc
  v_and_b32 v20, v25, v8
  v_and_b32 v21, v25, v9
  v_and_b32 v22, v25, v10
  v_and_b32 v23, v25, v11
  s_waitcnt vmcnt(4)
  s_nop 0
  v_mfma_f32_16x16x32_bf16 v[12:15], v[20:23], v[116:119], v[12:15]
  v_mfma_f32_16x16x32_bf16 v[16:19], v[20:23], v[120:123], v[16:19]
  s_mov_b32 s35, 147456
  buffer_load_dwordx4 v[76:79], v30, s[12:15], s35 offen offset:0 nt
  v_mov_b32_dpp v25, v42 row_newbcast:0 row_mask:0xf bank_mask:0x3
  v_mov_b32_dpp v25, v42 row_newbcast:8 row_mask:0xf bank_mask:0xc
  v_and_b32 v20, v25, v8
  v_and_b32 v21, v25, v9
  v_and_b32 v22, v25, v10
  v_and_b32 v23, v25, v11
  s_waitcnt vmcnt(3)
  s_nop 0
  v_mfma_f32_16x16x32_bf16 v[12:15], v[20:23], v[60:63], v[12:15]
  v_mfma_f32_16x16x32_bf16 v[16:19], v[20:23], v[64:67], v[16:19]
  s_mov_b32 s35, 147456
  buffer_load_dwordx4 v[80:83], v30, s[12:15], s35 offen offset:1024 nt
  s_mov_b32 s35, 155648
  buffer_load_dwordx4 v[84:87], v30, s[12:15], s35 offen offset:0 nt
  s_mov_b32 s35, 155648
  buffer_load_dwordx4 v[88:91], v30, s[12:15], s35 offen offset:1024 nt
  v_mov_b32_dpp v25, v42 row_newbcast:1 row_mask:0xf bank_mask:0x3
  v_mov_b32_dpp v25, v42 row_newbcast:9 row_mask:0xf bank_mask:0xc
  v_and_b32 v20, v25, v8
  v_and_b32 v21, v25, v9
  v_and_b32 v22, v25, v10
  v_and_b32 v23, v25, v11
  s_waitcnt vmcnt(4)
  s_nop 0
  v_mfma_f32_16x16x32_bf16 v[12:15], v[20:23], v[68:71], v[12:15]
  v_mfma_f32_16x16x32_bf16 v[16:19], v[20:23], v[72:75], v[16:19]
  s_mov_b32 s35, 163840
  buffer_load_dwordx4 v[92:95], v30, s[12:15], s35 offen offset:0 nt
  s_mov_b32 s35, 163840
  buffer_load_dwordx4 v[96:99], v30, s[12:15], s35 offen offset:1024 nt
  v_mov_b32_dpp v25, v42 row_newbcast:2 row_mask:0xf bank_mask:0x3
  v_mov_b32_dpp v25, v42 row_newbcast:10 row_mask:0xf bank_mask:0xc
  v_and_b32 v20, v25, v8
  v_and_b32 v21, v25, v9
  v_and_b32 v22, v25, v10
  v_and_b32 v23, v25, v11
  s_waitcnt vmcnt(4)
  s_nop 0
  v_mfma_f32_16x16x32_bf16 v[12:15], v[20:23], v[76:79], v[12:15]
  v_mfma_f32_16x16x32_bf16 v[16:19], v[20:23], v[80:83], v[16:19]
  s_mov_b32 s35, 172032
  buffer_load_dwordx4 v[100:103], v30, s[12:15], s35 offen offset:0 nt
  s_mov_b32 s35, 172032
  buffer_load_dwordx4 v[104:107], v30, s[12:15], s35 offen offset:1024 nt
  v_mov_b32_dpp v25, v42 row_newbcast:3 row_mask:0xf bank_mask:0x3
  v_mov_b32_dpp v25, v42 row_newbcast:11 row_mask:0xf bank_mask:0xc
  v_and_b32 v20, v25, v8
  v_and_b32 v21, v25, v9
  v_and_b32 v22, v25, v10
  v_and_b32 v23, v25, v11
  s_waitcnt vmcnt(4)
  s_nop 0
  v_mfma_f32_16x16x32_bf16 v[12:15], v[20:23], v[84:87], v[12:15]
  v_mfma_f32_16x16x32_bf16 v[16:19], v[20:23], v[88:91], v[16:19]
  s_mov_b32 s35, 180224
  buffer_load_dwordx4 v[108:111], v30, s[12:15], s35 offen offset:0 nt
  s_mov_b32 s35, 180224
  buffer_load_dwordx4 v[112:115], v30, s[12:15], s35 offen offset:1024 nt
  v_mov_b32_dpp v25, v42 row_newbcast:4 row_mask:0xf bank_mask:0x3
  v_mov_b32_dpp v25, v42 row_newbcast:12 row_mask:0xf bank_mask:0xc
  v_and_b32 v20, v25, v8
  v_and_b32 v21, v25, v9
  v_and_b32 v22, v25, v10
  v_and_b32 v23, v25, v11
  s_waitcnt vmcnt(4)
  s_nop 0
  v_mfma_f32_16x16x32_bf16 v[12:15], v[20:23], v[92:95], v[12:15]
  v_mfma_f32_16x16x32_bf16 v[16:19], v[20:23], v[96:99], v[16:19]
  s_mov_b32 s35, 188416
  buffer_load_dwordx4 v[116:119], v30, s[12:15], s35 offen offset:0 nt
  v_mov_b32_dpp v25, v42 row_newbcast:5 row_mask:0xf bank_mask:0x3
  v_mov_b32_dpp v25, v42 row_newbcast:13 row_mask:0xf bank_mask:0xc
  v_and_b32 v20, v25, v8
  v_and_b32 v21, v25, v9
  v_and_b32 v22, v25, v10
  v_and_b32 v23, v25, v11
  s_waitcnt vmcnt(3)
  s_nop 0
  v_mfma_f32_16x16x32_bf16 v[12:15], v[20:23], v[100:103], v[12:15]
  v_mfma_f32_16x16x32_bf16 v[16:19], v[20:23], v[104:107], v[16:19]
  s_mov_b32 s35, 188416
  buffer_load_dwordx4 v[120:123], v30, s[12:15], s35 offen offset:1024 nt
  s_mov_b32 s35, 196608
  buffer_load_dwordx4 v[60:63], v30, s[12:15], s35 offen offset:0 nt
  s_mov_b32 s35, 196608
  buffer_load_dwordx4 v[64:67], v30, s[12:15], s35 offen offset:1024 nt
  v_mov_b32_dpp v25, v42 row_newbcast:6 row_mask:0xf bank_mask:0x3
  v_mov_b32_dpp v25, v42 row_newbcast:14 row_mask:0xf bank_mask:0xc
  v_and_b32 v20, v25, v8
  v_and_b32 v21, v25, v9
  v_and_b32 v22, v25, v10
  v_and_b32 v23, v25, v11
  s_waitcnt vmcnt(4)
  s_nop 0
  v_mfma_f32_16x16x32_bf16 v[12:15], v[20:23], v[108:111], v[12:15]
  v_mfma_f32_16x16x32_bf16 v[16:19], v[20:23], v[112:115], v[16:19]
  s_mov_b32 s35, 204800
  buffer_load_dwordx4 v[68:71], v30, s[12:15], s35 offen offset:0 nt
  s_mov_b32 s35, 204800
  buffer_load_dwordx4 v[72:75], v30, s[12:15], s35 offen offset:1024 nt
  v_mov_b32_dpp v25, v42 row_newbcast:7 row_mask:0xf bank_mask:0x3
  v_mov_b32_dpp v25, v42 row_newbcast:15 row_mask:0xf bank_mask:0xc
  v_and_b32 v20, v25, v8
  v_and_b32 v21, v25, v9
  v_and_b32 v22, v25, v10
  v_and_b32 v23, v25, v11
  s_waitcnt vmcnt(4)
  s_nop 0
  v_mfma_f32_16x16x32_bf16 v[12:15], v[20:23], v[116:119], v[12:15]
  v_mfma_f32_16x16x32_bf16 v[16:19], v[20:23], v[120:123], v[16:19]
  s_mov_b32 s35, 212992
  buffer_load_dwordx4 v[76:79], v30, s[12:15], s35 offen offset:0 nt
  s_mov_b32 s35, 212992
  buffer_load_dwordx4 v[80:83], v30, s[12:15], s35 offen offset:1024 nt
  v_mov_b32_dpp v25, v43 row_newbcast:0 row_mask:0xf bank_mask:0x3
  v_mov_b32_dpp v25, v43 row_newbcast:8 row_mask:0xf bank_mask:0xc
  v_and_b32 v20, v25, v8
  v_and_b32 v21, v25, v9
  v_and_b32 v22, v25, v10
  v_and_b32 v23, v25, v11
  s_waitcnt vmcnt(4)
  s_nop 0
  v_mfma_f32_16x16x32_bf16 v[12:15], v[20:23], v[60:63], v[12:15]
  v_mfma_f32_16x16x32_bf16 v[16:19], v[20:23], v[64:67], v[16:19]
  s_mov_b32 s35, 221184
  buffer_load_dwordx4 v[84:87], v30, s[12:15], s35 offen offset:0 nt
  s_mov_b32 s35, 221184
  buffer_load_dwordx4 v[88:91], v30, s[12:15], s35 offen offset:1024 nt
  v_mov_b32_dpp v25, v43 row_newbcast:1 row_mask:0xf bank_mask:0x3
  v_mov_b32_dpp v25, v43 row_newbcast:9 row_mask:0xf bank_mask:0xc
  v_and_b32 v20, v25, v8
  v_and_b32 v21, v25, v9
  v_and_b32 v22, v25, v10
  v_and_b32 v23, v25, v11
  s_waitcnt vmcnt(4)
  s_nop 0
  v_mfma_f32_16x16x32_bf16 v[12:15], v[20:23], v[68:71], v[12:15]
  v_mfma_f32_16x16x32_bf16 v[16:19], v[20:23], v[72:75], v[16:19]
  s_mov_b32 s35, 229376
  buffer_load_dwordx4 v[92:95], v30, s[12:15], s35 offen offset:0 nt
  v_mov_b32_dpp v25, v43 row_newbcast:2 row_mask:0xf bank_mask:0x3
  v_mov_b32_dpp v25, v43 row_newbcast:10 row_mask:0xf bank_mask:0xc
  v_and_b32 v20, v25, v8
  v_and_b32 v21, v25, v9
  v_and_b32 v22, v25, v10
  v_and_b32 v23, v25, v11
  s_waitcnt vmcnt(3)
  s_nop 0
  v_mfma_f32_16x16x32_bf16 v[12:15], v[20:23], v[76:79], v[12:15]
  v_mfma_f32_16x16x32_bf16 v[16:19], v[20:23], v[80:83], v[16:19]
  s_mov_b32 s35, 229376
  buffer_load_dwordx4 v[96:99], v30, s[12:15], s35 offen offset:1024 nt
  s_mov_b32 s35, 237568
  buffer_load_dwordx4 v[100:103], v30, s[12:15], s35 offen offset:0 nt
  s_mov_b32 s35, 237568
  buffer_load_dwordx4 v[104:107], v30, s[12:15], s35 offen offset:1024 nt
  v_mov_b32_dpp v25, v43 row_newbcast:3 row_mask:0xf bank_mask:0x3
  v_mov_b32_dpp v25, v43 row_newbcast:11 row_mask:0xf bank_mask:0xc
  v_and_b32 v20, v25, v8
  v_and_b32 v21, v25, v9
  v_and_b32 v22, v25, v10
  v_and_b32 v23, v25, v11
  s_waitcnt vmcnt(4)
  s_nop 0
  v_mfma_f32_16x16x32_bf16 v[12:15], v[20:23], v[84:87], v[12:15]
  v_mfma_f32_16x16x32_bf16 v[16:19], v[20:23], v[88:91], v[16:19]
  s_mov_b32 s35, 245760
  buffer_load_dwordx4 v[108:111], v30, s[12:15], s35 offen offset:0 nt
  s_mov_b32 s35, 245760
  buffer_load_dwordx4 v[112:115], v30, s[12:15], s35 offen offset:1024 nt
  v_mov_b32_dpp v25, v43 row_newbcast:4 row_mask:0xf bank_mask:0x3
  v_mov_b32_dpp v25, v43 row_newbcast:12 row_mask:0xf bank_mask:0xc
  v_and_b32 v20, v25, v8
  v_and_b32 v21, v25, v9
  v_and_b32 v22, v25, v10
  v_and_b32 v23, v25, v11
  s_waitcnt vmcnt(4)
  s_nop 0
  v_mfma_f32_16x16x32_bf16 v[12:15], v[20:23], v[92:95], v[12:15]
  v_mfma_f32_16x16x32_bf16 v[16:19], v[20:23], v[96:99], v[16:19]
  s_mov_b32 s35, 253952
  buffer_load_dwordx4 v[116:119], v30, s[12:15], s35 offen offset:0 nt
  s_mov_b32 s35, 253952
  buffer_load_dwordx4 v[120:123], v30, s[12:15], s35 offen offset:1024 nt
  v_mov_b32_dpp v25, v43 row_newbcast:5 row_mask:0xf bank_mask:0x3
  v_mov_b32_dpp v25, v43 row_newbcast:13 row_mask:0xf bank_mask:0xc
  v_and_b32 v20, v25, v8
  v_and_b32 v21, v25, v9
  v_and_b32 v22, v25, v10
  v_and_b32 v23, v25, v11
  s_waitcnt vmcnt(4)
  s_nop 0
  v_mfma_f32_16x16x32_bf16 v[12:15], v[20:23], v[100:103], v[12:15]
  v_mfma_f32_16x16x32_bf16 v[16:19], v[20:23], v[104:107], v[16:19]
  s_mov_b32 s35, 262144
  buffer_load_dwordx4 v[60:63], v30, s[12:15], s35 offen offset:0 nt
  s_mov_b32 s35, 262144
  buffer_load_dwordx4 v[64:67], v30, s[12:15], s35 offen offset:1024 nt
  v_mov_b32_dpp v25, v43 row_newbcast:6 row_mask:0xf bank_mask:0x3
  v_mov_b32_dpp v25, v43 row_newbcast:14 row_mask:0xf bank_mask:0xc
  v_and_b32 v20, v25, v8
  v_and_b32 v21, v25, v9
  v_and_b32 v22, v25, v10
  v_and_b32 v23, v25, v11
  s_waitcnt vmcnt(4)
  s_nop 0
  v_mfma_f32_16x16x32_bf16 v[12:15], v[20:23], v[108:111], v[12:15]
  v_mfma_f32_16x16x32_bf16 v[16:19], v[20:23], v[112:115], v[16:19]
  s_mov_b32 s35, 270336
  buffer_load_dwordx4 v[68:71], v30, s[12:15], s35 offen offset:0 nt
  v_mov_b32_dpp v25, v43 row_newbcast:7 row_mask:0xf bank_mask:0x3
  v_mov_b32_dpp v25, v43 row_newbcast:15 row_mask:0xf bank_mask:0xc
  v_and_b32 v20, v25, v8
  v_and_b32 v21, v25, v9
  v_and_b32 v22, v25, v10
  v_and_b32 v23, v25, v11
  s_waitcnt vmcnt(3)
  s_nop 0
  v_mfma_f32_16x16x32_bf16 v[12:15], v[20:23], v[116:119], v[12:15]
  v_mfma_f32_16x16x32_bf16 v[16:19], v[20:23], v[120:123], v[16:19]
  s_mov_b32 s35, 270336
  buffer_load_dwordx4 v[72:75], v30, s[12:15], s35 offen offset:1024 nt
  s_mov_b32 s35, 278528
  buffer_load_dwordx4 v[76:79], v30, s[12:15], s35 offen offset:0 nt
  s_mov_b32 s35, 278528
  buffer_load_dwordx4 v[80:83], v30, s[12:15], s35 offen offset:1024 nt
  v_mov_b32_dpp v25, v44 row_newbcast:0 row_mask:0xf bank_mask:0x3
  v_mov_b32_dpp v25, v44 row_newbcast:8 row_mask:0xf bank_mask:0xc
  v_and_b32 v20, v25, v8
  v_and_b32 v21, v25, v9
  v_and_b32 v22, v25, v10
  v_and_b32 v23, v25, v11
  s_waitcnt vmcnt(4)
  s_nop 0
  v_mfma_f32_16x16x32_bf16 v[12:15], v[20:23], v[60:63], v[12:15]
  v_mfma_f32_16x16x32_bf16 v[16:19], v[20:23], v[64:67], v[16:19]
  s_mov_b32 s35, 286720
  buffer_load_dwordx4 v[84:87], v30, s[12:15], s35 offen offset:0 nt
  s_mov_b32 s35, 286720
  buffer_load_dwordx4 v[88:91], v30, s[12:15], s35 offen offset:1024 nt
  v_mov_b32_dpp v25, v44 row_newbcast:1 row_mask:0xf bank_mask:0x3
  v_mov_b32_dpp v25, v44 row_newbcast:9 row_mask:0xf bank_mask:0xc
  v_and_b32 v20, v25, v8
  v_and_b32 v21, v25, v9
  v_and_b32 v22, v25, v10
  v_and_b32 v23, v25, v11
  s_waitcnt vmcnt(4)
  s_nop 0
  v_mfma_f32_16x16x32_bf16 v[12:15], v[20:23], v[68:71], v[12:15]
  v_mfma_f32_16x16x32_bf16 v[16:19], v[20:23], v[72:75], v[16:19]
  s_mov_b32 s35, 294912
  buffer_load_dwordx4 v[92:95], v30, s[12:15], s35 offen offset:0 nt
  s_mov_b32 s35, 294912
  buffer_load_dwordx4 v[96:99], v30, s[12:15], s35 offen offset:1024 nt
  v_mov_b32_dpp v25, v44 row_newbcast:2 row_mask:0xf bank_mask:0x3
  v_mov_b32_dpp v25, v44 row_newbcast:10 row_mask:0xf bank_mask:0xc
  v_and_b32 v20, v25, v8
  v_and_b32 v21, v25, v9
  v_and_b32 v22, v25, v10
  v_and_b32 v23, v25, v11
  s_waitcnt vmcnt(4)
  s_nop 0
  v_mfma_f32_16x16x32_bf16 v[12:15], v[20:23], v[76:79], v[12:15]
  v_mfma_f32_16x16x32_bf16 v[16:19], v[20:23], v[80:83], v[16:19]
  s_mov_b32 s35, 303104
  buffer_load_dwordx4 v[100:103], v30, s[12:15], s35 offen offset:0 nt
  s_mov_b32 s35, 303104
  buffer_load_dwordx4 v[104:107], v30, s[12:15], s35 offen offset:1024 nt
  v_mov_b32_dpp v25, v44 row_newbcast:3 row_mask:0xf bank_mask:0x3
  v_mov_b32_dpp v25, v44 row_newbcast:11 row_mask:0xf bank_mask:0xc
  v_and_b32 v20, v25, v8
  v_and_b32 v21, v25, v9
  v_and_b32 v22, v25, v10
  v_and_b32 v23, v25, v11
  s_waitcnt vmcnt(4)
  s_nop 0
  v_mfma_f32_16x16x32_bf16 v[12:15], v[20:23], v[84:87], v[12:15]
  v_mfma_f32_16x16x32_bf16 v[16:19], v[20:23], v[88:91], v[16:19]
  s_mov_b32 s35, 311296
  buffer_load_dwordx4 v[108:111], v30, s[12:15], s35 offen offset:0 nt
  v_mov_b32_dpp v25, v44 row_newbcast:4 row_mask:0xf bank_mask:0x3
  v_mov_b32_dpp v25, v44 row_newbcast:12 row_mask:0xf bank_mask:0xc
  v_and_b32 v20, v25, v8
  v_and_b32 v21, v25, v9
  v_and_b32 v22, v25, v10
  v_and_b32 v23, v25, v11
  s_waitcnt vmcnt(3)
  s_nop 0
  v_mfma_f32_16x16x32_bf16 v[12:15], v[20:23], v[92:95], v[12:15]
  v_mfma_f32_16x16x32_bf16 v[16:19], v[20:23], v[96:99], v[16:19]
  s_mov_b32 s35, 311296
  buffer_load_dwordx4 v[112:115], v30, s[12:15], s35 offen offset:1024 nt
  s_mov_b32 s35, 319488
  buffer_load_dwordx4 v[116:119], v30, s[12:15], s35 offen offset:0 nt
  s_mov_b32 s35, 319488
  buffer_load_dwordx4 v[120:123], v30, s[12:15], s35 offen offset:1024 nt
  v_mov_b32_dpp v25, v44 row_newbcast:5 row_mask:0xf bank_mask:0x3
  v_mov_b32_dpp v25, v44 row_newbcast:13 row_mask:0xf bank_mask:0xc
  v_and_b32 v20, v25, v8
  v_and_b32 v21, v25, v9
  v_and_b32 v22, v25, v10
  v_and_b32 v23, v25, v11
  s_waitcnt vmcnt(4)
  s_nop 0
  v_mfma_f32_16x16x32_bf16 v[12:15], v[20:23], v[100:103], v[12:15]
  v_mfma_f32_16x16x32_bf16 v[16:19], v[20:23], v[104:107], v[16:19]
  s_mov_b32 s35, 327680
  buffer_load_dwordx4 v[60:63], v30, s[12:15], s35 offen offset:0 nt
  s_mov_b32 s35, 327680
  buffer_load_dwordx4 v[64:67], v30, s[12:15], s35 offen offset:1024 nt
  v_mov_b32_dpp v25, v44 row_newbcast:6 row_mask:0xf bank_mask:0x3
  v_mov_b32_dpp v25, v44 row_newbcast:14 row_mask:0xf bank_mask:0xc
  v_and_b32 v20, v25, v8
  v_and_b32 v21, v25, v9
  v_and_b32 v22, v25, v10
  v_and_b32 v23, v25, v11
  s_waitcnt vmcnt(4)
  s_nop 0
  v_mfma_f32_16x16x32_bf16 v[12:15], v[20:23], v[108:111], v[12:15]
  v_mfma_f32_16x16x32_bf16 v[16:19], v[20:23], v[112:115], v[16:19]
  s_mov_b32 s35, 335872
  buffer_load_dwordx4 v[68:71], v30, s[12:15], s35 offen offset:0 nt
  s_mov_b32 s35, 335872
  buffer_load_dwordx4 v[72:75], v30, s[12:15], s35 offen offset:1024 nt
  v_mov_b32_dpp v25, v44 row_newbcast:7 row_mask:0xf bank_mask:0x3
  v_mov_b32_dpp v25, v44 row_newbcast:15 row_mask:0xf bank_mask:0xc
  v_and_b32 v20, v25, v8
  v_and_b32 v21, v25, v9
  v_and_b32 v22, v25, v10
  v_and_b32 v23, v25, v11
  s_waitcnt vmcnt(4)
  s_nop 0
  v_mfma_f32_16x16x32_bf16 v[12:15], v[20:23], v[116:119], v[12:15]
  v_mfma_f32_16x16x32_bf16 v[16:19], v[20:23], v[120:123], v[16:19]
  s_mov_b32 s35, 344064
  buffer_load_dwordx4 v[76:79], v30, s[12:15], s35 offen offset:0 nt
  s_mov_b32 s35, 344064
  buffer_load_dwordx4 v[80:83], v30, s[12:15], s35 offen offset:1024 nt
  v_mov_b32_dpp v25, v45 row_newbcast:0 row_mask:0xf bank_mask:0x3
  v_mov_b32_dpp v25, v45 row_newbcast:8 row_mask:0xf bank_mask:0xc
  v_and_b32 v20, v25, v8
  v_and_b32 v21, v25, v9
  v_and_b32 v22, v25, v10
  v_and_b32 v23, v25, v11
  s_waitcnt vmcnt(4)
  s_nop 0
  v_mfma_f32_16x16x32_bf16 v[12:15], v[20:23], v[60:63], v[12:15]
  v_mfma_f32_16x16x32_bf16 v[16:19], v[20:23], v[64:67], v[16:19]
  s_mov_b32 s35, 352256
  buffer_load_dwordx4 v[84:87], v30, s[12:15], s35 offen offset:0 nt
  v_mov_b32_dpp v25, v45 row_newbcast:1 row_mask:0xf bank_mask:0x3
  v_mov_b32_dpp v25, v45 row_newbcast:9 row_mask:0xf bank_mask:0xc
  v_and_b32 v20, v25, v8
  v_and_b32 v21, v25, v9
  v_and_b32 v22, v25, v10
  v_and_b32 v23, v25, v11
  s_waitcnt vmcnt(3)
  s_nop 0
  v_mfma_f32_16x16x32_bf16 v[12:15], v[20:23], v[68:71], v[12:15]
  v_mfma_f32_16x16x32_bf16 v[16:19], v[20:23], v[72:75], v[16:19]
  s_mov_b32 s35, 352256
  buffer_load_dwordx4 v[88:91], v30, s[12:15], s35 offen offset:1024 nt
  s_mov_b32 s35, 360448
  buffer_load_dwordx4 v[92:95], v30, s[12:15], s35 offen offset:0 nt
  s_mov_b32 s35, 360448
  buffer_load_dwordx4 v[96:99], v30, s[12:15], s35 offen offset:1024 nt
  v_mov_b32_dpp v25, v45 row_newbcast:2 row_mask:0xf bank_mask:0x3
  v_mov_b32_dpp v25, v45 row_newbcast:10 row_mask:0xf bank_mask:0xc
  v_and_b32 v20, v25, v8
  v_and_b32 v21, v25, v9
  v_and_b32 v22, v25, v10
  v_and_b32 v23, v25, v11
  s_waitcnt vmcnt(4)
  s_nop 0
  v_mfma_f32_16x16x32_bf16 v[12:15], v[20:23], v[76:79], v[12:15]
  v_mfma_f32_16x16x32_bf16 v[16:19], v[20:23], v[80:83], v[16:19]
  s_mov_b32 s35, 368640
  buffer_load_dwordx4 v[100:103], v30, s[12:15], s35 offen offset:0 nt
  s_mov_b32 s35, 368640
  buffer_load_dwordx4 v[104:107], v30, s[12:15], s35 offen offset:1024 nt
  v_mov_b32_dpp v25, v45 row_newbcast:3 row_mask:0xf bank_mask:0x3
  v_mov_b32_dpp v25, v45 row_newbcast:11 row_mask:0xf bank_mask:0xc
  v_and_b32 v20, v25, v8
  v_and_b32 v21, v25, v9
  v_and_b32 v22, v25, v10
  v_and_b32 v23, v25, v11
  s_waitcnt vmcnt(4)
  s_nop 0
  v_mfma_f32_16x16x32_bf16 v[12:15], v[20:23], v[84:87], v[12:15]
  v_mfma_f32_16x16x32_bf16 v[16:19], v[20:23], v[88:91], v[16:19]
  s_mov_b32 s35, 376832
  buffer_load_dwordx4 v[108:111], v30, s[12:15], s35 offen offset:0 nt
  s_mov_b32 s35, 376832
  buffer_load_dwordx4 v[112:115], v30, s[12:15], s35 offen offset:1024 nt
  v_mov_b32_dpp v25, v45 row_newbcast:4 row_mask:0xf bank_mask:0x3
  v_mov_b32_dpp v25, v45 row_newbcast:12 row_mask:0xf bank_mask:0xc
  v_and_b32 v20, v25, v8
  v_and_b32 v21, v25, v9
  v_and_b32 v22, v25, v10
  v_and_b32 v23, v25, v11
  s_waitcnt vmcnt(4)
  s_nop 0
  v_mfma_f32_16x16x32_bf16 v[12:15], v[20:23], v[92:95], v[12:15]
  v_mfma_f32_16x16x32_bf16 v[16:19], v[20:23], v[96:99], v[16:19]
  s_mov_b32 s35, 385024
  buffer_load_dwordx4 v[116:119], v30, s[12:15], s35 offen offset:0 nt
  s_mov_b32 s35, 385024
  buffer_load_dwordx4 v[120:123], v30, s[12:15], s35 offen offset:1024 nt
  v_mov_b32_dpp v25, v45 row_newbcast:5 row_mask:0xf bank_mask:0x3
  v_mov_b32_dpp v25, v45 row_newbcast:13 row_mask:0xf bank_mask:0xc
  v_and_b32 v20, v25, v8
  v_and_b32 v21, v25, v9
  v_and_b32 v22, v25, v10
  v_and_b32 v23, v25, v11
  s_waitcnt vmcnt(4)
  s_nop 0
  v_mfma_f32_16x16x32_bf16 v[12:15], v[20:23], v[100:103], v[12:15]
  v_mfma_f32_16x16x32_bf16 v[16:19], v[20:23], v[104:107], v[16:19]
  s_mov_b32 s35, 393216
  buffer_load_dwordx4 v[60:63], v30, s[12:15], s35 offen offset:0 nt
  v_mov_b32_dpp v25, v45 row_newbcast:6 row_mask:0xf bank_mask:0x3
  v_mov_b32_dpp v25, v45 row_newbcast:14 row_mask:0xf bank_mask:0xc
  v_and_b32 v20, v25, v8
  v_and_b32 v21, v25, v9
  v_and_b32 v22, v25, v10
  v_and_b32 v23, v25, v11
  s_waitcnt vmcnt(3)
  s_nop 0
  v_mfma_f32_16x16x32_bf16 v[12:15], v[20:23], v[108:111], v[12:15]
  v_mfma_f32_16x16x32_bf16 v[16:19], v[20:23], v[112:115], v[16:19]
  s_mov_b32 s35, 393216
  buffer_load_dwordx4 v[64:67], v30, s[12:15], s35 offen offset:1024 nt
  s_mov_b32 s35, 401408
  buffer_load_dwordx4 v[68:71], v30, s[12:15], s35 offen offset:0 nt
  s_mov_b32 s35, 401408
  buffer_load_dwordx4 v[72:75], v30, s[12:15], s35 offen offset:1024 nt
  v_mov_b32_dpp v25, v45 row_newbcast:7 row_mask:0xf bank_mask:0x3
  v_mov_b32_dpp v25, v45 row_newbcast:15 row_mask:0xf bank_mask:0xc
  v_and_b32 v20, v25, v8
  v_and_b32 v21, v25, v9
  v_and_b32 v22, v25, v10
  v_and_b32 v23, v25, v11
  s_waitcnt vmcnt(4)
  s_nop 0
  v_mfma_f32_16x16x32_bf16 v[12:15], v[20:23], v[116:119], v[12:15]
  v_mfma_f32_16x16x32_bf16 v[16:19], v[20:23], v[120:123], v[16:19]
  s_mov_b32 s35, 409600
  buffer_load_dwordx4 v[76:79], v30, s[12:15], s35 offen offset:0 nt
  s_mov_b32 s35, 409600
  buffer_load_dwordx4 v[80:83], v30, s[12:15], s35 offen offset:1024 nt
  v_mov_b32_dpp v25, v46 row_newbcast:0 row_mask:0xf bank_mask:0x3
  v_mov_b32_dpp v25, v46 row_newbcast:8 row_mask:0xf bank_mask:0xc
  v_and_b32 v20, v25, v8
  v_and_b32 v21, v25, v9
  v_and_b32 v22, v25, v10
  v_and_b32 v23, v25, v11
  s_waitcnt vmcnt(4)
  s_nop 0
  v_mfma_f32_16x16x32_bf16 v[12:15], v[20:23], v[60:63], v[12:15]
  v_mfma_f32_16x16x32_bf16 v[16:19], v[20:23], v[64:67], v[16:19]
  s_mov_b32 s35, 417792
  buffer_load_dwordx4 v[84:87], v30, s[12:15], s35 offen offset:0 nt
  s_mov_b32 s35, 417792
  buffer_load_dwordx4 v[88:91], v30, s[12:15], s35 offen offset:1024 nt
  v_mov_b32_dpp v25, v46 row_newbcast:1 row_mask:0xf bank_mask:0x3
  v_mov_b32_dpp v25, v46 row_newbcast:9 row_mask:0xf bank_mask:0xc
  v_and_b32 v20, v25, v8
  v_and_b32 v21, v25, v9
  v_and_b32 v22, v25, v10
  v_and_b32 v23, v25, v11
  s_waitcnt vmcnt(4)
  s_nop 0
  v_mfma_f32_16x16x32_bf16 v[12:15], v[20:23], v[68:71], v[12:15]
  v_mfma_f32_16x16x32_bf16 v[16:19], v[20:23], v[72:75], v[16:19]
  s_mov_b32 s35, 425984
  buffer_load_dwordx4 v[92:95], v30, s[12:15], s35 offen offset:0 nt
  s_mov_b32 s35, 425984
  buffer_load_dwordx4 v[96:99], v30, s[12:15], s35 offen offset:1024 nt
  v_mov_b32_dpp v25, v46 row_newbcast:2 row_mask:0xf bank_mask:0x3
  v_mov_b32_dpp v25, v46 row_newbcast:10 row_mask:0xf bank_mask:0xc
  v_and_b32 v20, v25, v8
  v_and_b32 v21, v25, v9
  v_and_b32 v22, v25, v10
  v_and_b32 v23, v25, v11
  s_waitcnt vmcnt(4)
  s_nop 0
  v_mfma_f32_16x16x32_bf16 v[12:15], v[20:23], v[76:79], v[12:15]
  v_mfma_f32_16x16x32_bf16 v[16:19], v[20:23], v[80:83], v[16:19]
  s_mov_b32 s35, 434176
  buffer_load_dwordx4 v[100:103], v30, s[12:15], s35 offen offset:0 nt
  v_mov_b32_dpp v25, v46 row_newbcast:3 row_mask:0xf bank_mask:0x3
  v_mov_b32_dpp v25, v46 row_newbcast:11 row_mask:0xf bank_mask:0xc
  v_and_b32 v20, v25, v8
  v_and_b32 v21, v25, v9
  v_and_b32 v22, v25, v10
  v_and_b32 v23, v25, v11
  s_waitcnt vmcnt(3)
  s_nop 0
  v_mfma_f32_16x16x32_bf16 v[12:15], v[20:23], v[84:87], v[12:15]
  v_mfma_f32_16x16x32_bf16 v[16:19], v[20:23], v[88:91], v[16:19]
  s_mov_b32 s35, 434176
  buffer_load_dwordx4 v[104:107], v30, s[12:15], s35 offen offset:1024 nt
  s_mov_b32 s35, 442368
  buffer_load_dwordx4 v[108:111], v30, s[12:15], s35 offen offset:0 nt
  s_mov_b32 s35, 442368
  buffer_load_dwordx4 v[112:115], v30, s[12:15], s35 offen offset:1024 nt
  v_mov_b32_dpp v25, v46 row_newbcast:4 row_mask:0xf bank_mask:0x3
  v_mov_b32_dpp v25, v46 row_newbcast:12 row_mask:0xf bank_mask:0xc
  v_and_b32 v20, v25, v8
  v_and_b32 v21, v25, v9
  v_and_b32 v22, v25, v10
  v_and_b32 v23, v25, v11
  s_waitcnt vmcnt(4)
  s_nop 0
  v_mfma_f32_16x16x32_bf16 v[12:15], v[20:23], v[92:95], v[12:15]
  v_mfma_f32_16x16x32_bf16 v[16:19], v[20:23], v[96:99], v[16:19]
  s_mov_b32 s35, 450560
  buffer_load_dwordx4 v[116:119], v30, s[12:15], s35 offen offset:0 nt
  s_mov_b32 s35, 450560
  buffer_load_dwordx4 v[120:123], v30, s[12:15], s35 offen offset:1024 nt
  v_mov_b32_dpp v25, v46 row_newbcast:5 row_mask:0xf bank_mask:0x3
  v_mov_b32_dpp v25, v46 row_newbcast:13 row_mask:0xf bank_mask:0xc
  v_and_b32 v20, v25, v8
  v_and_b32 v21, v25, v9
  v_and_b32 v22, v25, v10
  v_and_b32 v23, v25, v11
  s_waitcnt vmcnt(4)
  s_nop 0
  v_mfma_f32_16x16x32_bf16 v[12:15], v[20:23], v[100:103], v[12:15]
  v_mfma_f32_16x16x32_bf16 v[16:19], v[20:23], v[104:107], v[16:19]
  s_mov_b32 s35, 458752
  buffer_load_dwordx4 v[60:63], v30, s[12:15], s35 offen offset:0 nt
  s_mov_b32 s35, 458752
  buffer_load_dwordx4 v[64:67], v30, s[12:15], s35 offen offset:1024 nt
  v_mov_b32_dpp v25, v46 row_newbcast:6 row_mask:0xf bank_mask:0x3
  v_mov_b32_dpp v25, v46 row_newbcast:14 row_mask:0xf bank_mask:0xc
  v_and_b32 v20, v25, v8
  v_and_b32 v21, v25, v9
  v_and_b32 v22, v25, v10
  v_and_b32 v23, v25, v11
  s_waitcnt vmcnt(4)
  s_nop 0
  v_mfma_f32_16x16x32_bf16 v[12:15], v[20:23], v[108:111], v[12:15]
  v_mfma_f32_16x16x32_bf16 v[16:19], v[20:23], v[112:115], v[16:19]
  s_mov_b32 s35, 466944
  buffer_load_dwordx4 v[68:71], v30, s[12:15], s35 offen offset:0 nt
  s_mov_b32 s35, 466944
  buffer_load_dwordx4 v[72:75], v30, s[12:15], s35 offen offset:1024 nt
  v_mov_b32_dpp v25, v46 row_newbcast:7 row_mask:0xf bank_mask:0x3
  v_mov_b32_dpp v25, v46 row_newbcast:15 row_mask:0xf bank_mask:0xc
  v_and_b32 v20, v25, v8
  v_and_b32 v21, v25, v9
  v_and_b32 v22, v25, v10
  v_and_b32 v23, v25, v11
  s_waitcnt vmcnt(4)
  s_nop 0
  v_mfma_f32_16x16x32_bf16 v[12:15], v[20:23], v[116:119], v[12:15]
  v_mfma_f32_16x16x32_bf16 v[16:19], v[20:23], v[120:123], v[16:19]
  s_mov_b32 s35, 475136
  buffer_load_dwordx4 v[76:79], v30, s[12:15], s35 offen offset:0 nt
  v_mov_b32_dpp v25, v47 row_newbcast:0 row_mask:0xf bank_mask:0x3
  v_mov_b32_dpp v25, v47 row_newbcast:8 row_mask:0xf bank_mask:0xc
  v_and_b32 v20, v25, v8
  v_and_b32 v21, v25, v9
  v_and_b32 v22, v25, v10
  v_and_b32 v23, v25, v11
  s_waitcnt vmcnt(3)
  s_nop 0
  v_mfma_f32_16x16x32_bf16 v[12:15], v[20:23], v[60:63], v[12:15]
  v_mfma_f32_16x16x32_bf16 v[16:19], v[20:23], v[64:67], v[16:19]
  s_mov_b32 s35, 475136
  buffer_load_dwordx4 v[80:83], v30, s[12:15], s35 offen offset:1024 nt
  s_mov_b32 s35, 483328
  buffer_load_dwordx4 v[84:87], v30, s[12:15], s35 offen offset:0 nt
  s_mov_b32 s35, 483328
  buffer_load_dwordx4 v[88:91], v30, s[12:15], s35 offen offset:1024 nt
  v_mov_b32_dpp v25, v47 row_newbcast:1 row_mask:0xf bank_mask:0x3
  v_mov_b32_dpp v25, v47 row_newbcast:9 row_mask:0xf bank_mask:0xc
  v_and_b32 v20, v25, v8
  v_and_b32 v21, v25, v9
  v_and_b32 v22, v25, v10
  v_and_b32 v23, v25, v11
  s_waitcnt vmcnt(4)
  s_nop 0
  v_mfma_f32_16x16x32_bf16 v[12:15], v[20:23], v[68:71], v[12:15]
  v_mfma_f32_16x16x32_bf16 v[16:19], v[20:23], v[72:75], v[16:19]
  s_mov_b32 s35, 491520
  buffer_load_dwordx4 v[92:95], v30, s[12:15], s35 offen offset:0 nt
  s_mov_b32 s35, 491520
  buffer_load_dwordx4 v[96:99], v30, s[12:15], s35 offen offset:1024 nt
  v_mov_b32_dpp v25, v47 row_newbcast:2 row_mask:0xf bank_mask:0x3
  v_mov_b32_dpp v25, v47 row_newbcast:10 row_mask:0xf bank_mask:0xc
  v_and_b32 v20, v25, v8
  v_and_b32 v21, v25, v9
  v_and_b32 v22, v25, v10
  v_and_b32 v23, v25, v11
  s_waitcnt vmcnt(4)
  s_nop 0
  v_mfma_f32_16x16x32_bf16 v[12:15], v[20:23], v[76:79], v[12:15]
  v_mfma_f32_16x16x32_bf16 v[16:19], v[20:23], v[80:83], v[16:19]
  s_mov_b32 s35, 499712
  buffer_load_dwordx4 v[100:103], v30, s[12:15], s35 offen offset:0 nt
  s_mov_b32 s35, 499712
  buffer_load_dwordx4 v[104:107], v30, s[12:15], s35 offen offset:1024 nt
  v_mov_b32_dpp v25, v47 row_newbcast:3 row_mask:0xf bank_mask:0x3
  v_mov_b32_dpp v25, v47 row_newbcast:11 row_mask:0xf bank_mask:0xc
  v_and_b32 v20, v25, v8
  v_and_b32 v21, v25, v9
  v_and_b32 v22, v25, v10
  v_and_b32 v23, v25, v11
  s_waitcnt vmcnt(4)
  s_nop 0
  v_mfma_f32_16x16x32_bf16 v[12:15], v[20:23], v[84:87], v[12:15]
  v_mfma_f32_16x16x32_bf16 v[16:19], v[20:23], v[88:91], v[16:19]
  s_mov_b32 s35, 507904
  buffer_load_dwordx4 v[108:111], v30, s[12:15], s35 offen offset:0 nt
  s_mov_b32 s35, 507904
  buffer_load_dwordx4 v[112:115], v30, s[12:15], s35 offen offset:1024 nt
  v_mov_b32_dpp v25, v47 row_newbcast:4 row_mask:0xf bank_mask:0x3
  v_mov_b32_dpp v25, v47 row_newbcast:12 row_mask:0xf bank_mask:0xc
  v_and_b32 v20, v25, v8
  v_and_b32 v21, v25, v9
  v_and_b32 v22, v25, v10
  v_and_b32 v23, v25, v11
  s_waitcnt vmcnt(4)
  s_nop 0
  v_mfma_f32_16x16x32_bf16 v[12:15], v[20:23], v[92:95], v[12:15]
  v_mfma_f32_16x16x32_bf16 v[16:19], v[20:23], v[96:99], v[16:19]
  s_mov_b32 s35, 516096
  buffer_load_dwordx4 v[116:119], v30, s[12:15], s35 offen offset:0 nt
  v_mov_b32_dpp v25, v47 row_newbcast:5 row_mask:0xf bank_mask:0x3
  v_mov_b32_dpp v25, v47 row_newbcast:13 row_mask:0xf bank_mask:0xc
  v_and_b32 v20, v25, v8
  v_and_b32 v21, v25, v9
  v_and_b32 v22, v25, v10
  v_and_b32 v23, v25, v11
  s_waitcnt vmcnt(3)
  s_nop 0
  v_mfma_f32_16x16x32_bf16 v[12:15], v[20:23], v[100:103], v[12:15]
  v_mfma_f32_16x16x32_bf16 v[16:19], v[20:23], v[104:107], v[16:19]
  s_mov_b32 s35, 516096
  buffer_load_dwordx4 v[120:123], v30, s[12:15], s35 offen offset:1024 nt
  buffer_load_dwordx4 v[60:63], v30, s[16:19], 0 offen offset:0 nt
  buffer_load_dwordx4 v[64:67], v30, s[16:19], 0 offen offset:1024 nt
  v_mov_b32_dpp v25, v47 row_newbcast:6 row_mask:0xf bank_mask:0x3
  v_mov_b32_dpp v25, v47 row_newbcast:14 row_mask:0xf bank_mask:0xc
  v_and_b32 v20, v25, v8
  v_and_b32 v21, v25, v9
  v_and_b32 v22, v25, v10
  v_and_b32 v23, v25, v11
  s_waitcnt vmcnt(4)
  s_nop 0
  v_mfma_f32_16x16x32_bf16 v[12:15], v[20:23], v[108:111], v[12:15]
  v_mfma_f32_16x16x32_bf16 v[16:19], v[20:23], v[112:115], v[16:19]
  s_mov_b32 s35, 8192
  buffer_load_dwordx4 v[68:71], v30, s[16:19], s35 offen offset:0 nt
  s_mov_b32 s35, 8192
  buffer_load_dwordx4 v[72:75], v30, s[16:19], s35 offen offset:1024 nt
  v_mov_b32_dpp v25, v47 row_newbcast:7 row_mask:0xf bank_mask:0x3
  v_mov_b32_dpp v25, v47 row_newbcast:15 row_mask:0xf bank_mask:0xc
  v_and_b32 v20, v25, v8
  v_and_b32 v21, v25, v9
  v_and_b32 v22, v25, v10
  v_and_b32 v23, v25, v11
  s_waitcnt vmcnt(4)
  s_nop 0
  v_mfma_f32_16x16x32_bf16 v[12:15], v[20:23], v[116:119], v[12:15]
  v_mfma_f32_16x16x32_bf16 v[16:19], v[20:23], v[120:123], v[16:19]
  s_mov_b32 s35, 16384
  buffer_load_dwordx4 v[76:79], v30, s[16:19], s35 offen offset:0 nt
  s_mov_b32 s35, 16384
  buffer_load_dwordx4 v[80:83], v30, s[16:19], s35 offen offset:1024 nt
  v_and_b32 v2, 63, v0
  v_cmp_gt_u32 vcc, 32, v2
  v_lshlrev_b32 v1, 4, v0
  v_add_u32 v1, s40, v1
  s_nop 7
  v_cndmask_b32 v20, v16, v12, vcc
  v_cndmask_b32 v21, v17, v13, vcc
  v_cndmask_b32 v22, v18, v14, vcc
  v_cndmask_b32 v23, v19, v15, vcc
  ds_write_b128 v1, v[20:23]
  s_add_u32 s40, s40, 4224
  s_mov_b32 s12, s16
  s_mov_b32 s13, s17
  s_add_u32 s32, s32, 1
  s_add_u32 s35, s32, 1
  s_cmp_ge_u32 s35, 4
  s_cselect_b32 s16, s22, s20
  s_cselect_b32 s17, s23, s21
  s_and_b32 s43, s35, 3
  s_mul_i32 s43, s43, 134217728
  s_add_u32 s16, s16, s43
  s_addc_u32 s17, s17, 0
  s_cmp_ge_u32 s35, 8
  s_cselect_b32 s18, 0, s42
  s_cmp_lt_u32 s32, 7
  s_cbranch_scc1 L_vhead
L_vlast:
  ds_read_b128 v[40:43], v37 offset:0
  ds_read_b128 v[44:47], v37 offset:1024
  v_add_u32 v37, 8192, v37
  s_waitcnt lgkmcnt(0)
  v_mov_b32_dpp v25, v40 row_newbcast:0 row_mask:0xf bank_mask:0x3
  v_mov_b32_dpp v25, v40 row_newbcast:8 row_mask:0xf bank_mask:0xc
  v_and_b32 v20, v25, v8
  v_and_b32 v21, v25, v9
  v_and_b32 v22, v25, v10
  v_and_b32 v23, v25, v11
  s_waitcnt vmcnt(4)
  s_nop 0
  v_mfma_f32_16x16x32_bf16 v[12:15], v[20:23], v[60:63], 0
  v_mfma_f32_16x16x32_bf16 v[16:19], v[20:23], v[64:67], 0
  s_mov_b32 s35, 24576
  buffer_load_dwordx4 v[84:87], v30, s[12:15], s35 offen offset:0 nt
  v_mov_b32_dpp v25, v40 row_newbcast:1 row_mask:0xf bank_mask:0x3
  v_mov_b32_dpp v25, v40 row_newbcast:9 row_mask:0xf bank_mask:0xc
  v_and_b32 v20, v25, v8
  v_and_b32 v21, v25, v9
  v_and_b32 v22, v25, v10
  v_and_b32 v23, v25, v11
  s_waitcnt vmcnt(3)
  s_nop 0
  v_mfma_f32_16x16x32_bf16 v[12:15], v[20:23], v[68:71], v[12:15]
  v_mfma_f32_16x16x32_bf16 v[16:19], v[20:23], v[72:75], v[16:19]
  s_mov_b32 s35, 24576
  buffer_load_dwordx4 v[88:91], v30, s[12:15], s35 offen offset:1024 nt
  s_mov_b32 s35, 32768
  buffer_load_dwordx4 v[92:95], v30, s[12:15], s35 offen offset:0 nt
  s_mov_b32 s35, 32768
  buffer_load_dwordx4 v[96:99], v30, s[12:15], s35 offen offset:1024 nt
  v_mov_b32_dpp v25, v40 row_newbcast:2 row_mask:0xf bank_mask:0x3
  v_mov_b32_dpp v25, v40 row_newbcast:10 row_mask:0xf bank_mask:0xc
  v_and_b32 v20, v25, v8
  v_and_b32 v21, v25, v9
  v_and_b32 v22, v25, v10
  v_and_b32 v23, v25, v11
  s_waitcnt vmcnt(4)
  s_nop 0
  v_mfma_f32_16x16x32_bf16 v[12:15], v[20:23], v[76:79], v[12:15]
  v_mfma_f32_16x16x32_bf16 v[16:19], v[20:23], v[80:83], v[16:19]
  s_mov_b32 s35, 40960
  buffer_load_dwordx4 v[100:103], v30, s[12:15], s35 offen offset:0 nt
  s_mov_b32 s35, 40960
  buffer_load_dwordx4 v[104:107], v30, s[12:15], s35 offen offset:1024 nt
  v_mov_b32_dpp v25, v40 row_newbcast:3 row_mask:0xf bank_mask:0x3
  v_mov_b32_dpp v25, v40 row_newbcast:11 row_mask:0xf bank_mask:0xc
  v_and_b32 v20, v25, v8
  v_and_b32 v21, v25, v9
  v_and_b32 v22, v25, v10
  v_and_b32 v23, v25, v11
  s_waitcnt vmcnt(4)
  s_nop 0
  v_mfma_f32_16x16x32_bf16 v[12:15], v[20:23], v[84:87], v[12:15]
  v_mfma_f32_16x16x32_bf16 v[16:19], v[20:23], v[88:91], v[16:19]
  s_mov_b32 s35, 49152
  buffer_load_dwordx4 v[108:111], v30, s[12:15], s35 offen offset:0 nt
  s_mov_b32 s35, 49152
  buffer_load_dwordx4 v[112:115], v30, s[12:15], s35 offen offset:1024 nt
  v_mov_b32_dpp v25, v40 row_newbcast:4 row_mask:0xf bank_mask:0x3
  v_mov_b32_dpp v25, v40 row_newbcast:12 row_mask:0xf bank_mask:0xc
  v_and_b32 v20, v25, v8
  v_and_b32 v21, v25, v9
  v_and_b32 v22, v25, v10
  v_and_b32 v23, v25, v11
  s_waitcnt vmcnt(4)
  s_nop 0
  v_mfma_f32_16x16x32_bf16 v[12:15], v[20:23], v[92:95], v[12:15]
  v_mfma_f32_16x16x32_bf16 v[16:19], v[20:23], v[96:99], v[16:19]
  s_mov_b32 s35, 57344
  buffer_load_dwordx4 v[116:119], v30, s[12:15], s35 offen offset:0 nt
  s_mov_b32 s35, 57344
  buffer_load_dwordx4 v[120:123], v30, s[12:15], s35 offen offset:1024 nt
  v_mov_b32_dpp v25, v40 row_newbcast:5 row_mask:0xf bank_mask:0x3
  v_mov_b32_dpp v25, v40 row_newbcast:13 row_mask:0xf bank_mask:0xc
  v_and_b32 v20, v25, v8
  v_and_b32 v21, v25, v9
  v_and_b32 v22, v25, v10
  v_and_b32 v23, v25, v11
  s_waitcnt vmcnt(4)
  s_nop 0
  v_mfma_f32_16x16x32_bf16 v[12:15], v[20:23], v[100:103], v[12:15]
  v_mfma_f32_16x16x32_bf16 v[16:19], v[20:23], v[104:107], v[16:19]
  s_mov_b32 s35, 65536
  buffer_load_dwordx4 v[60:63], v30, s[12:15], s35 offen offset:0 nt
  v_mov_b32_dpp v25, v40 row_newbcast:6 row_mask:0xf bank_mask:0x3
  v_mov_b32_dpp v25, v40 row_newbcast:14 row_mask:0xf bank_mask:0xc
  v_and_b32 v20, v25, v8
  v_and_b32 v21, v25, v9
  v_and_b32 v22, v25, v10
  v_and_b32 v23, v25, v11
  s_waitcnt vmcnt(3)
  s_nop 0
  v_mfma_f32_16x16x32_bf16 v[12:15], v[20:23], v[108:111], v[12:15]
  v_mfma_f32_16x16x32_bf16 v[16:19], v[20:23], v[112:115], v[16:19]
  s_mov_b32 s35, 65536
  buffer_load_dwordx4 v[64:67], v30, s[12:15], s35 offen offset:1024 nt
  s_mov_b32 s35, 73728
  buffer_load_dwordx4 v[68:71], v30, s[12:15], s35 offen offset:0 nt
  s_mov_b32 s35, 73728
  buffer_load_dwordx4 v[72:75], v30, s[12:15], s35 offen offset:1024 nt
  v_mov_b32_dpp v25, v40 row_newbcast:7 row_mask:0xf bank_mask:0x3
  v_mov_b32_dpp v25, v40 row_newbcast:15 row_mask:0xf bank_mask:0xc
  v_and_b32 v20, v25, v8
  v_and_b32 v21, v25, v9
  v_and_b32 v22, v25, v10
  v_and_b32 v23, v25, v11
  s_waitcnt vmcnt(4)
  s_nop 0
  v_mfma_f32_16x16x32_bf16 v[12:15], v[20:23], v[116:119], v[12:15]
  v_mfma_f32_16x16x32_bf16 v[16:19], v[20:23], v[120:123], v[16:19]
  s_mov_b32 s35, 81920
  buffer_load_dwordx4 v[76:79], v30, s[12:15], s35 offen offset:0 nt
  s_mov_b32 s35, 81920
  buffer_load_dwordx4 v[80:83], v30, s[12:15], s35 offen offset:1024 nt
  v_mov_b32_dpp v25, v41 row_newbcast:0 row_mask:0xf bank_mask:0x3
  v_mov_b32_dpp v25, v41 row_newbcast:8 row_mask:0xf bank_mask:0xc
  v_and_b32 v20, v25, v8
  v_and_b32 v21, v25, v9
  v_and_b32 v22, v25, v10
  v_and_b32 v23, v25, v11
  s_waitcnt vmcnt(4)
  s_nop 0
  v_mfma_f32_16x16x32_bf16 v[12:15], v[20:23], v[60:63], v[12:15]
  v_mfma_f32_16x16x32_bf16 v[16:19], v[20:23], v[64:67], v[16:19]
  s_mov_b32 s35, 90112
  buffer_load_dwordx4 v[84:87], v30, s[12:15], s35 offen offset:0 nt
  s_mov_b32 s35, 90112
  buffer_load_dwordx4 v[88:91], v30, s[12:15], s35 offen offset:1024 nt
  v_mov_b32_dpp v25, v41 row_newbcast:1 row_mask:0xf bank_mask:0x3
  v_mov_b32_dpp v25, v41 row_newbcast:9 row_mask:0xf bank_mask:0xc
  v_and_b32 v20, v25, v8
  v_and_b32 v21, v25, v9
  v_and_b32 v22, v25, v10
  v_and_b32 v23, v25, v11
  s_waitcnt vmcnt(4)
  s_nop 0
  v_mfma_f32_16x16x32_bf16 v[12:15], v[20:23], v[68:71], v[12:15]
  v_mfma_f32_16x16x32_bf16 v[16:19], v[20:23], v[72:75], v[16:19]
  s_mov_b32 s35, 98304
  buffer_load_dwordx4 v[92:95], v30, s[12:15], s35 offen offset:0 nt
  s_mov_b32 s35, 98304
  buffer_load_dwordx4 v[96:99], v30, s[12:15], s35 offen offset:1024 nt
  v_mov_b32_dpp v25, v41 row_newbcast:2 row_mask:0xf bank_mask:0x3
  v_mov_b32_dpp v25, v41 row_newbcast:10 row_mask:0xf bank_mask:0xc
  v_and_b32 v20, v25, v8
  v_and_b32 v21, v25, v9
  v_and_b32 v22, v25, v10
  v_and_b32 v23, v25, v11
  s_waitcnt vmcnt(4)
  s_nop 0
  v_mfma_f32_16x16x32_bf16 v[12:15], v[20:23], v[76:79], v[12:15]
  v_mfma_f32_16x16x32_bf16 v[16:19], v[20:23], v[80:83], v[16:19]
  s_mov_b32 s35, 106496
  buffer_load_dwordx4 v[100:103], v30, s[12:15], s35 offen offset:0 nt
  v_mov_b32_dpp v25, v41 row_newbcast:3 row_mask:0xf bank_mask:0x3
  v_mov_b32_dpp v25, v41 row_newbcast:11 row_mask:0xf bank_mask:0xc
  v_and_b32 v20, v25, v8
  v_and_b32 v21, v25, v9
  v_and_b32 v22, v25, v10
  v_and_b32 v23, v25, v11
  s_waitcnt vmcnt(3)
  s_nop 0
  v_mfma_f32_16x16x32_bf16 v[12:15], v[20:23], v[84:87], v[12:15]
  v_mfma_f32_16x16x32_bf16 v[16:19], v[20:23], v[88:91], v[16:19]
  s_mov_b32 s35, 106496
  buffer_load_dwordx4 v[104:107], v30, s[12:15], s35 offen offset:1024 nt
  s_mov_b32 s35, 114688
  buffer_load_dwordx4 v[108:111], v30, s[12:15], s35 offen offset:0 nt
  s_mov_b32 s35, 114688
  buffer_load_dwordx4 v[112:115], v30, s[12:15], s35 offen offset:1024 nt
  v_mov_b32_dpp v25, v41 row_newbcast:4 row_mask:0xf bank_mask:0x3
  v_mov_b32_dpp v25, v41 row_newbcast:12 row_mask:0xf bank_mask:0xc
  v_and_b32 v20, v25, v8
  v_and_b32 v21, v25, v9
  v_and_b32 v22, v25, v10
  v_and_b32 v23, v25, v11
  s_waitcnt vmcnt(4)
  s_nop 0
  v_mfma_f32_16x16x32_bf16 v[12:15], v[20:23], v[92:95], v[12:15]
  v_mfma_f32_16x16x32_bf16 v[16:19], v[20:23], v[96:99], v[16:19]
  s_mov_b32 s35, 122880
  buffer_load_dwordx4 v[116:119], v30, s[12:15], s35 offen offset:0 nt
  s_mov_b32 s35, 122880
  buffer_load_dwordx4 v[120:123], v30, s[12:15], s35 offen offset:1024 nt
  v_mov_b32_dpp v25, v41 row_newbcast:5 row_mask:0xf bank_mask:0x3
  v_mov_b32_dpp v25, v41 row_newbcast:13 row_mask:0xf bank_mask:0xc
  v_and_b32 v20, v25, v8
  v_and_b32 v21, v25, v9
  v_and_b32 v22, v25, v10
  v_and_b32 v23, v25, v11
  s_waitcnt vmcnt(4)
  s_nop 0
  v_mfma_f32_16x16x32_bf16 v[12:15], v[20:23], v[100:103], v[12:15]
  v_mfma_f32_16x16x32_bf16 v[16:19], v[20:23], v[104:107], v[16:19]
  s_mov_b32 s35, 131072
  buffer_load_dwordx4 v[60:63], v30, s[12:15], s35 offen offset:0 nt
  s_mov_b32 s35, 131072
  buffer_load_dwordx4 v[64:67], v30, s[12:15], s35 offen offset:1024 nt
  v_mov_b32_dpp v25, v41 row_newbcast:6 row_mask:0xf bank_mask:0x3
  v_mov_b32_dpp v25, v41 row_newbcast:14 row_mask:0xf bank_mask:0xc
  v_and_b32 v20, v25, v8
  v_and_b32 v21, v25, v9
  v_and_b32 v22, v25, v10
  v_and_b32 v23, v25, v11
  s_waitcnt vmcnt(4)
  s_nop 0
  v_mfma_f32_16x16x32_bf16 v[12:15], v[20:23], v[108:111], v[12:15]
  v_mfma_f32_16x16x32_bf16 v[16:19], v[20:23], v[112:115], v[16:19]
  s_mov_b32 s35, 139264
  buffer_load_dwordx4 v[68:71], v30, s[12:15], s35 offen offset:0 nt
  s_mov_b32 s35, 139264
  buffer_load_dwordx4 v[72:75], v30, s[12:15], s35 offen offset:1024 nt
  v_mov_b32_dpp v25, v41 row_newbcast:7 row_mask:0xf bank_mask:0x3
  v_mov_b32_dpp v25, v41 row_newbcast:15 row_mask:0xf bank_mask:0xc
  v_and_b32 v20, v25, v8
  v_and_b32 v21, v25, v9
  v_and_b32 v22, v25, v10
  v_and_b32 v23, v25, v11
  s_waitcnt vmcnt(4)
  s_nop 0
  v_mfma_f32_16x16x32_bf16 v[12:15], v[20:23], v[116:119], v[12:15]
  v_mfma_f32_16x16x32_bf16 v[16:19], v[20:23], v[120:123], v[16:19]
  s_mov_b32 s35, 147456
  buffer_load_dwordx4 v[76:79], v30, s[12:15], s35 offen offset:0 nt
  v_mov_b32_dpp v25, v42 row_newbcast:0 row_mask:0xf bank_mask:0x3
  v_mov_b32_dpp v25, v42 row_newbcast:8 row_mask:0xf bank_mask:0xc
  v_and_b32 v20, v25, v8
  v_and_b32 v21, v25, v9
  v_and_b32 v22, v25, v10
  v_and_b32 v23, v25, v11
  s_waitcnt vmcnt(3)
  s_nop 0
  v_mfma_f32_16x16x32_bf16 v[12:15], v[20:23], v[60:63], v[12:15]
  v_mfma_f32_16x16x32_bf16 v[16:19], v[20:23], v[64:67], v[16:19]
  s_mov_b32 s35, 147456
  buffer_load_dwordx4 v[80:83], v30, s[12:15], s35 offen offset:1024 nt
  s_mov_b32 s35, 155648
  buffer_load_dwordx4 v[84:87], v30, s[12:15], s35 offen offset:0 nt
  s_mov_b32 s35, 155648
  buffer_load_dwordx4 v[88:91], v30, s[12:15], s35 offen offset:1024 nt
  v_mov_b32_dpp v25, v42 row_newbcast:1 row_mask:0xf bank_mask:0x3
  v_mov_b32_dpp v25, v42 row_newbcast:9 row_mask:0xf bank_mask:0xc
  v_and_b32 v20, v25, v8
  v_and_b32 v21, v25, v9
  v_and_b32 v22, v25, v10
  v_and_b32 v23, v25, v11
  s_waitcnt vmcnt(4)
  s_nop 0
  v_mfma_f32_16x16x32_bf16 v[12:15], v[20:23], v[68:71], v[12:15]
  v_mfma_f32_16x16x32_bf16 v[16:19], v[20:23], v[72:75], v[16:19]
  s_mov_b32 s35, 163840
  buffer_load_dwordx4 v[92:95], v30, s[12:15], s35 offen offset:0 nt
  s_mov_b32 s35, 163840
  buffer_load_dwordx4 v[96:99], v30, s[12:15], s35 offen offset:1024 nt
  v_mov_b32_dpp v25, v42 row_newbcast:2 row_mask:0xf bank_mask:0x3
  v_mov_b32_dpp v25, v42 row_newbcast:10 row_mask:0xf bank_mask:0xc
  v_and_b32 v20, v25, v8
  v_and_b32 v21, v25, v9
  v_and_b32 v22, v25, v10
  v_and_b32 v23, v25, v11
  s_waitcnt vmcnt(4)
  s_nop 0
  v_mfma_f32_16x16x32_bf16 v[12:15], v[20:23], v[76:79], v[12:15]
  v_mfma_f32_16x16x32_bf16 v[16:19], v[20:23], v[80:83], v[16:19]
  s_mov_b32 s35, 172032
  buffer_load_dwordx4 v[100:103], v30, s[12:15], s35 offen offset:0 nt
  s_mov_b32 s35, 172032
  buffer_load_dwordx4 v[104:107], v30, s[12:15], s35 offen offset:1024 nt
  v_mov_b32_dpp v25, v42 row_newbcast:3 row_mask:0xf bank_mask:0x3
  v_mov_b32_dpp v25, v42 row_newbcast:11 row_mask:0xf bank_mask:0xc
  v_and_b32 v20, v25, v8
  v_and_b32 v21, v25, v9
  v_and_b32 v22, v25, v10
  v_and_b32 v23, v25, v11
  s_waitcnt vmcnt(4)
  s_nop 0
  v_mfma_f32_16x16x32_bf16 v[12:15], v[20:23], v[84:87], v[12:15]
  v_mfma_f32_16x16x32_bf16 v[16:19], v[20:23], v[88:91], v[16:19]
  s_mov_b32 s35, 180224
  buffer_load_dwordx4 v[108:111], v30, s[12:15], s35 offen offset:0 nt
  s_mov_b32 s35, 180224
  buffer_load_dwordx4 v[112:115], v30, s[12:15], s35 offen offset:1024 nt
  v_mov_b32_dpp v25, v42 row_newbcast:4 row_mask:0xf bank_mask:0x3
  v_mov_b32_dpp v25, v42 row_newbcast:12 row_mask:0xf bank_mask:0xc
  v_and_b32 v20, v25, v8
  v_and_b32 v21, v25, v9
  v_and_b32 v22, v25, v10
  v_and_b32 v23, v25, v11
  s_waitcnt vmcnt(4)
  s_nop 0
  v_mfma_f32_16x16x32_bf16 v[12:15], v[20:23], v[92:95], v[12:15]
  v_mfma_f32_16x16x32_bf16 v[16:19], v[20:23], v[96:99], v[16:19]
  s_mov_b32 s35, 188416
  buffer_load_dwordx4 v[116:119], v30, s[12:15], s35 offen offset:0 nt
  v_mov_b32_dpp v25, v42 row_newbcast:5 row_mask:0xf bank_mask:0x3
  v_mov_b32_dpp v25, v42 row_newbcast:13 row_mask:0xf bank_mask:0xc
  v_and_b32 v20, v25, v8
  v_and_b32 v21, v25, v9
  v_and_b32 v22, v25, v10
  v_and_b32 v23, v25, v11
  s_waitcnt vmcnt(3)
  s_nop 0
  v_mfma_f32_16x16x32_bf16 v[12:15], v[20:23], v[100:103], v[12:15]
  v_mfma_f32_16x16x32_bf16 v[16:19], v[20:23], v[104:107], v[16:19]
  s_mov_b32 s35, 188416
  buffer_load_dwordx4 v[120:123], v30, s[12:15], s35 offen offset:1024 nt
  s_mov_b32 s35, 196608
  buffer_load_dwordx4 v[60:63], v30, s[12:15], s35 offen offset:0 nt
  s_mov_b32 s35, 196608
  buffer_load_dwordx4 v[64:67], v30, s[12:15], s35 offen offset:1024 nt
  v_mov_b32_dpp v25, v42 row_newbcast:6 row_mask:0xf bank_mask:0x3
  v_mov_b32_dpp v25, v42 row_newbcast:14 row_mask:0xf bank_mask:0xc
  v_and_b32 v20, v25, v8
  v_and_b32 v21, v25, v9
  v_and_b32 v22, v25, v10
  v_and_b32 v23, v25, v11
  s_waitcnt vmcnt(4)
  s_nop 0
  v_mfma_f32_16x16x32_bf16 v[12:15], v[20:23], v[108:111], v[12:15]
  v_mfma_f32_16x16x32_bf16 v[16:19], v[20:23], v[112:115], v[16:19]
  s_mov_b32 s35, 204800
  buffer_load_dwordx4 v[68:71], v30, s[12:15], s35 offen offset:0 nt
  s_mov_b32 s35, 204800
  buffer_load_dwordx4 v[72:75], v30, s[12:15], s35 offen offset:1024 nt
  v_mov_b32_dpp v25, v42 row_newbcast:7 row_mask:0xf bank_mask:0x3
  v_mov_b32_dpp v25, v42 row_newbcast:15 row_mask:0xf bank_mask:0xc
  v_and_b32 v20, v25, v8
  v_and_b32 v21, v25, v9
  v_and_b32 v22, v25, v10
  v_and_b32 v23, v25, v11
  s_waitcnt vmcnt(4)
  s_nop 0
  v_mfma_f32_16x16x32_bf16 v[12:15], v[20:23], v[116:119], v[12:15]
  v_mfma_f32_16x16x32_bf16 v[16:19], v[20:23], v[120:123], v[16:19]
  s_mov_b32 s35, 212992
  buffer_load_dwordx4 v[76:79], v30, s[12:15], s35 offen offset:0 nt
  s_mov_b32 s35, 212992
  buffer_load_dwordx4 v[80:83], v30, s[12:15], s35 offen offset:1024 nt
  v_mov_b32_dpp v25, v43 row_newbcast:0 row_mask:0xf bank_mask:0x3
  v_mov_b32_dpp v25, v43 row_newbcast:8 row_mask:0xf bank_mask:0xc
  v_and_b32 v20, v25, v8
  v_and_b32 v21, v25, v9
  v_and_b32 v22, v25, v10
  v_and_b32 v23, v25, v11
  s_waitcnt vmcnt(4)
  s_nop 0
  v_mfma_f32_16x16x32_bf16 v[12:15], v[20:23], v[60:63], v[12:15]
  v_mfma_f32_16x16x32_bf16 v[16:19], v[20:23], v[64:67], v[16:19]
  s_mov_b32 s35, 221184
  buffer_load_dwordx4 v[84:87], v30, s[12:15], s35 offen offset:0 nt
  s_mov_b32 s35, 221184
  buffer_load_dwordx4 v[88:91], v30, s[12:15], s35 offen offset:1024 nt
  v_mov_b32_dpp v25, v43 row_newbcast:1 row_mask:0xf bank_mask:0x3
  v_mov_b32_dpp v25, v43 row_newbcast:9 row_mask:0xf bank_mask:0xc
  v_and_b32 v20, v25, v8
  v_and_b32 v21, v25, v9
  v_and_b32 v22, v25, v10
  v_and_b32 v23, v25, v11
  s_waitcnt vmcnt(4)
  s_nop 0
  v_mfma_f32_16x16x32_bf16 v[12:15], v[20:23], v[68:71], v[12:15]
  v_mfma_f32_16x16x32_bf16 v[16:19], v[20:23], v[72:75], v[16:19]
  s_mov_b32 s35, 229376
  buffer_load_dwordx4 v[92:95], v30, s[12:15], s35 offen offset:0 nt
  v_mov_b32_dpp v25, v43 row_newbcast:2 row_mask:0xf bank_mask:0x3
  v_mov_b32_dpp v25, v43 row_newbcast:10 row_mask:0xf bank_mask:0xc
  v_and_b32 v20, v25, v8
  v_and_b32 v21, v25, v9
  v_and_b32 v22, v25, v10
  v_and_b32 v23, v25, v11
  s_waitcnt vmcnt(3)
  s_nop 0
  v_mfma_f32_16x16x32_bf16 v[12:15], v[20:23], v[76:79], v[12:15]
  v_mfma_f32_16x16x32_bf16 v[16:19], v[20:23], v[80:83], v[16:19]
  s_mov_b32 s35, 229376
  buffer_load_dwordx4 v[96:99], v30, s[12:15], s35 offen offset:1024 nt
  s_mov_b32 s35, 237568
  buffer_load_dwordx4 v[100:103], v30, s[12:15], s35 offen offset:0 nt
  s_mov_b32 s35, 237568
  buffer_load_dwordx4 v[104:107], v30, s[12:15], s35 offen offset:1024 nt
  v_mov_b32_dpp v25, v43 row_newbcast:3 row_mask:0xf bank_mask:0x3
  v_mov_b32_dpp v25, v43 row_newbcast:11 row_mask:0xf bank_mask:0xc
  v_and_b32 v20, v25, v8
  v_and_b32 v21, v25, v9
  v_and_b32 v22, v25, v10
  v_and_b32 v23, v25, v11
  s_waitcnt vmcnt(4)
  s_nop 0
  v_mfma_f32_16x16x32_bf16 v[12:15], v[20:23], v[84:87], v[12:15]
  v_mfma_f32_16x16x32_bf16 v[16:19], v[20:23], v[88:91], v[16:19]
  s_mov_b32 s35, 245760
  buffer_load_dwordx4 v[108:111], v30, s[12:15], s35 offen offset:0 nt
  s_mov_b32 s35, 245760
  buffer_load_dwordx4 v[112:115], v30, s[12:15], s35 offen offset:1024 nt
  v_mov_b32_dpp v25, v43 row_newbcast:4 row_mask:0xf bank_mask:0x3
  v_mov_b32_dpp v25, v43 row_newbcast:12 row_mask:0xf bank_mask:0xc
  v_and_b32 v20, v25, v8
  v_and_b32 v21, v25, v9
  v_and_b32 v22, v25, v10
  v_and_b32 v23, v25, v11
  s_waitcnt vmcnt(4)
  s_nop 0
  v_mfma_f32_16x16x32_bf16 v[12:15], v[20:23], v[92:95], v[12:15]
  v_mfma_f32_16x16x32_bf16 v[16:19], v[20:23], v[96:99], v[16:19]
  s_mov_b32 s35, 253952
  buffer_load_dwordx4 v[116:119], v30, s[12:15], s35 offen offset:0 nt
  s_mov_b32 s35, 253952
  buffer_load_dwordx4 v[120:123], v30, s[12:15], s35 offen offset:1024 nt
  v_mov_b32_dpp v25, v43 row_newbcast:5 row_mask:0xf bank_mask:0x3
  v_mov_b32_dpp v25, v43 row_newbcast:13 row_mask:0xf bank_mask:0xc
  v_and_b32 v20, v25, v8
  v_and_b32 v21, v25, v9
  v_and_b32 v22, v25, v10
  v_and_b32 v23, v25, v11
  s_waitcnt vmcnt(4)
  s_nop 0
  v_mfma_f32_16x16x32_bf16 v[12:15], v[20:23], v[100:103], v[12:15]
  v_mfma_f32_16x16x32_bf16 v[16:19], v[20:23], v[104:107], v[16:19]
  s_mov_b32 s35, 262144
  buffer_load_dwordx4 v[60:63], v30, s[12:15], s35 offen offset:0 nt
  s_mov_b32 s35, 262144
  buffer_load_dwordx4 v[64:67], v30, s[12:15], s35 offen offset:1024 nt
  v_mov_b32_dpp v25, v43 row_newbcast:6 row_mask:0xf bank_mask:0x3
  v_mov_b32_dpp v25, v43 row_newbcast:14 row_mask:0xf bank_mask:0xc
  v_and_b32 v20, v25, v8
  v_and_b32 v21, v25, v9
  v_and_b32 v22, v25, v10
  v_and_b32 v23, v25, v11
  s_waitcnt vmcnt(4)
  s_nop 0
  v_mfma_f32_16x16x32_bf16 v[12:15], v[20:23], v[108:111], v[12:15]
  v_mfma_f32_16x16x32_bf16 v[16:19], v[20:23], v[112:115], v[16:19]
  s_mov_b32 s35, 270336
  buffer_load_dwordx4 v[68:71], v30, s[12:15], s35 offen offset:0 nt
  v_mov_b32_dpp v25, v43 row_newbcast:7 row_mask:0xf bank_mask:0x3
  v_mov_b32_dpp v25, v43 row_newbcast:15 row_mask:0xf bank_mask:0xc
  v_and_b32 v20, v25, v8
  v_and_b32 v21, v25, v9
  v_and_b32 v22, v25, v10
  v_and_b32 v23, v25, v11
  s_waitcnt vmcnt(3)
  s_nop 0
  v_mfma_f32_16x16x32_bf16 v[12:15], v[20:23], v[116:119], v[12:15]
  v_mfma_f32_16x16x32_bf16 v[16:19], v[20:23], v[120:123], v[16:19]
  s_mov_b32 s35, 270336
  buffer_load_dwordx4 v[72:75], v30, s[12:15], s35 offen offset:1024 nt
  s_mov_b32 s35, 278528
  buffer_load_dwordx4 v[76:79], v30, s[12:15], s35 offen offset:0 nt
  s_mov_b32 s35, 278528
  buffer_load_dwordx4 v[80:83], v30, s[12:15], s35 offen offset:1024 nt
  v_mov_b32_dpp v25, v44 row_newbcast:0 row_mask:0xf bank_mask:0x3
  v_mov_b32_dpp v25, v44 row_newbcast:8 row_mask:0xf bank_mask:0xc
  v_and_b32 v20, v25, v8
  v_and_b32 v21, v25, v9
  v_and_b32 v22, v25, v10
  v_and_b32 v23, v25, v11
  s_waitcnt vmcnt(4)
  s_nop 0
  v_mfma_f32_16x16x32_bf16 v[12:15], v[20:23], v[60:63], v[12:15]
  v_mfma_f32_16x16x32_bf16 v[16:19], v[20:23], v[64:67], v[16:19]
  s_mov_b32 s35, 286720
  buffer_load_dwordx4 v[84:87], v30, s[12:15], s35 offen offset:0 nt
  s_mov_b32 s35, 286720
  buffer_load_dwordx4 v[88:91], v30, s[12:15], s35 offen offset:1024 nt
  s_mov_b32 s35, 294912
  buffer_load_dwordx4 v[92:95], v30, s[12:15], s35 offen offset:0 nt
  s_mov_b32 s35, 294912
  buffer_load_dwordx4 v[96:99], v30, s[12:15], s35 offen offset:1024 nt
  s_mov_b32 s35, 303104
  buffer_load_dwordx4 v[100:103], v30, s[12:15], s35 offen offset:0 nt
  s_mov_b32 s35, 303104
  buffer_load_dwordx4 v[104:107], v30, s[12:15], s35 offen offset:1024 nt
  s_mov_b32 s35, 311296
  buffer_load_dwordx4 v[108:111], v30, s[12:15], s35 offen offset:0 nt
  s_mov_b32 s35, 311296
  buffer_load_dwordx4 v[112:115], v30, s[12:15], s35 offen offset:1024 nt
  s_mov_b32 s35, 319488
  buffer_load_dwordx4 v[116:119], v30, s[12:15], s35 offen offset:0 nt
  s_mov_b32 s35, 319488
  buffer_load_dwordx4 v[120:123], v30, s[12:15], s35 offen offset:1024 nt
  s_mov_b32 s35, 327680
  buffer_load_dwordx4 v[60:63], v30, s[12:15], s35 offen offset:0 nt
  s_mov_b32 s35, 327680
  buffer_load_dwordx4 v[64:67], v30, s[12:15], s35 offen offset:1024 nt
  v_mov_b32_dpp v25, v44 row_newbcast:1 row_mask:0xf bank_mask:0x3
  v_mov_b32_dpp v25, v44 row_newbcast:9 row_mask:0xf bank_mask:0xc
  v_and_b32 v20, v25, v8
  v_and_b32 v21, v25, v9
  v_and_b32 v22, v25, v10
  v_and_b32 v23, v25, v11
  s_waitcnt vmcnt(14)
  s_nop 0
  v_mfma_f32_16x16x32_bf16 v[12:15], v[20:23], v[68:71], v[12:15]
  v_mfma_f32_16x16x32_bf16 v[16:19], v[20:23], v[72:75], v[16:19]
  s_mov_b32 s35, 335872
  buffer_load_dwordx4 v[68:71], v30, s[12:15], s35 offen offset:0 nt
  s_mov_b32 s35, 335872
  buffer_load_dwordx4 v[72:75], v30, s[12:15], s35 offen offset:1024 nt
  v_mov_b32_dpp v25, v44 row_newbcast:2 row_mask:0xf bank_mask:0x3
  v_mov_b32_dpp v25, v44 row_newbcast:10 row_mask:0xf bank_mask:0xc
  v_and_b32 v20, v25, v8
  v_and_b32 v21, v25, v9
  v_and_b32 v22, v25, v10
  v_and_b32 v23, v25, v11
  s_waitcnt vmcnt(14)
  s_nop 0
  v_mfma_f32_16x16x32_bf16 v[12:15], v[20:23], v[76:79], v[12:15]
  v_mfma_f32_16x16x32_bf16 v[16:19], v[20:23], v[80:83], v[16:19]
  s_mov_b32 s35, 344064
  buffer_load_dwordx4 v[76:79], v30, s[12:15], s35 offen offset:0 nt
  s_mov_b32 s35, 344064
  buffer_load_dwordx4 v[80:83], v30, s[12:15], s35 offen offset:1024 nt
  v_mov_b32_dpp v25, v44 row_newbcast:3 row_mask:0xf bank_mask:0x3
  v_mov_b32_dpp v25, v44 row_newbcast:11 row_mask:0xf bank_mask:0xc
  v_and_b32 v20, v25, v8
  v_and_b32 v21, v25, v9
  v_and_b32 v22, v25, v10
  v_and_b32 v23, v25, v11
  s_waitcnt vmcnt(14)
  s_nop 0
  v_mfma_f32_16x16x32_bf16 v[12:15], v[20:23], v[84:87], v[12:15]
  v_mfma_f32_16x16x32_bf16 v[16:19], v[20:23], v[88:91], v[16:19]
  s_mov_b32 s35, 352256
  buffer_load_dwordx4 v[84:87], v30, s[12:15], s35 offen offset:0 nt
  s_mov_b32 s35, 352256
  buffer_load_dwordx4 v[88:91], v30, s[12:15], s35 offen offset:1024 nt
  v_mov_b32_dpp v25, v44 row_newbcast:4 row_mask:0xf bank_mask:0x3
  v_mov_b32_dpp v25, v44 row_newbcast:12 row_mask:0xf bank_mask:0xc
  v_and_b32 v20, v25, v8
  v_and_b32 v21, v25, v9
  v_and_b32 v22, v25, v10
  v_and_b32 v23, v25, v11
  s_waitcnt vmcnt(14)
  s_nop 0
  v_mfma_f32_16x16x32_bf16 v[12:15], v[20:23], v[92:95], v[12:15]
  v_mfma_f32_16x16x32_bf16 v[16:19], v[20:23], v[96:99], v[16:19]
  s_mov_b32 s35, 360448
  buffer_load_dwordx4 v[92:95], v30, s[12:15], s35 offen offset:0 nt
  s_mov_b32 s35, 360448
  buffer_load_dwordx4 v[96:99], v30, s[12:15], s35 offen offset:1024 nt
  v_mov_b32_dpp v25, v44 row_newbcast:5 row_mask:0xf bank_mask:0x3
  v_mov_b32_dpp v25, v44 row_newbcast:13 row_mask:0xf bank_mask:0xc
  v_and_b32 v20, v25, v8
  v_and_b32 v21, v25, v9
  v_and_b32 v22, v25, v10
  v_and_b32 v23, v25, v11
  s_waitcnt vmcnt(14)
  s_nop 0
  v_mfma_f32_16x16x32_bf16 v[12:15], v[20:23], v[100:103], v[12:15]
  v_mfma_f32_16x16x32_bf16 v[16:19], v[20:23], v[104:107], v[16:19]
  s_mov_b32 s35, 368640
  buffer_load_dwordx4 v[100:103], v30, s[12:15], s35 offen offset:0 nt
  s_mov_b32 s35, 368640
  buffer_load_dwordx4 v[104:107], v30, s[12:15], s35 offen offset:1024 nt
  v_mov_b32_dpp v25, v44 row_newbcast:6 row_mask:0xf bank_mask:0x3
  v_mov_b32_dpp v25, v44 row_newbcast:14 row_mask:0xf bank_mask:0xc
  v_and_b32 v20, v25, v8
  v_and_b32 v21, v25, v9
  v_and_b32 v22, v25, v10
  v_and_b32 v23, v25, v11
  s_waitcnt vmcnt(14)
  s_nop 0
  v_mfma_f32_16x16x32_bf16 v[12:15], v[20:23], v[108:111], v[12:15]
  v_mfma_f32_16x16x32_bf16 v[16:19], v[20:23], v[112:115], v[16:19]
  s_mov_b32 s35, 376832
  buffer_load_dwordx4 v[108:111], v30, s[12:15], s35 offen offset:0 nt
  s_mov_b32 s35, 376832
  buffer_load_dwordx4 v[112:115], v30, s[12:15], s35 offen offset:1024 nt
  v_mov_b32_dpp v25, v44 row_newbcast:7 row_mask:0xf bank_mask:0x3
  v_mov_b32_dpp v25, v44 row_newbcast:15 row_mask:0xf bank_mask:0xc
  v_and_b32 v20, v25, v8
  v_and_b32 v21, v25, v9
  v_and_b32 v22, v25, v10
  v_and_b32 v23, v25, v11
  s_waitcnt vmcnt(14)
  s_nop 0
  v_mfma_f32_16x16x32_bf16 v[12:15], v[20:23], v[116:119], v[12:15]
  v_mfma_f32_16x16x32_bf16 v[16:19], v[20:23], v[120:123], v[16:19]
  s_mov_b32 s35, 385024
  buffer_load_dwordx4 v[116:119], v30, s[12:15], s35 offen offset:0 nt
  s_mov_b32 s35, 385024
  buffer_load_dwordx4 v[120:123], v30, s[12:15], s35 offen offset:1024 nt
  v_mov_b32_dpp v25, v45 row_newbcast:0 row_mask:0xf bank_mask:0x3
  v_mov_b32_dpp v25, v45 row_newbcast:8 row_mask:0xf bank_mask:0xc
  v_and_b32 v20, v25, v8
  v_and_b32 v21, v25, v9
  v_and_b32 v22, v25, v10
  v_and_b32 v23, v25, v11
  s_waitcnt vmcnt(14)
  s_nop 0
  v_mfma_f32_16x16x32_bf16 v[12:15], v[20:23], v[60:63], v[12:15]
  v_mfma_f32_16x16x32_bf16 v[16:19], v[20:23], v[64:67], v[16:19]
  s_mov_b32 s35, 393216
  buffer_load_dwordx4 v[60:63], v30, s[12:15], s35 offen offset:0 nt
  s_mov_b32 s35, 393216
  buffer_load_dwordx4 v[64:67], v30, s[12:15], s35 offen offset:1024 nt
  v_mov_b32_dpp v25, v45 row_newbcast:1 row_mask:0xf bank_mask:0x3
  v_mov_b32_dpp v25, v45 row_newbcast:9 row_mask:0xf bank_mask:0xc
  v_and_b32 v20, v25, v8
  v_and_b32 v21, v25, v9
  v_and_b32 v22, v25, v10
  v_and_b32 v23, v25, v11
  s_waitcnt vmcnt(14)
  s_nop 0
  v_mfma_f32_16x16x32_bf16 v[12:15], v[20:23], v[68:71], v[12:15]
  v_mfma_f32_16x16x32_bf16 v[16:19], v[20:23], v[72:75], v[16:19]
  s_mov_b32 s35, 401408
  buffer_load_dwordx4 v[68:71], v30, s[12:15], s35 offen offset:0 nt
  s_mov_b32 s35, 401408
  buffer_load_dwordx4 v[72:75], v30, s[12:15], s35 offen offset:1024 nt
  v_mov_b32_dpp v25, v45 row_newbcast:2 row_mask:0xf bank_mask:0x3
  v_mov_b32_dpp v25, v45 row_newbcast:10 row_mask:0xf bank_mask:0xc
  v_and_b32 v20, v25, v8
  v_and_b32 v21, v25, v9
  v_and_b32 v22, v25, v10
  v_and_b32 v23, v25, v11
  s_waitcnt vmcnt(14)
  s_nop 0
  v_mfma_f32_16x16x32_bf16 v[12:15], v[20:23], v[76:79], v[12:15]
  v_mfma_f32_16x16x32_bf16 v[16:19], v[20:23], v[80:83], v[16:19]
  s_mov_b32 s35, 409600
  buffer_load_dwordx4 v[76:79], v30, s[12:15], s35 offen offset:0 nt
  s_mov_b32 s35, 409600
  buffer_load_dwordx4 v[80:83], v30, s[12:15], s35 offen offset:1024 nt
  v_mov_b32_dpp v25, v45 row_newbcast:3 row_mask:0xf bank_mask:0x3
  v_mov_b32_dpp v25, v45 row_newbcast:11 row_mask:0xf bank_mask:0xc
  v_and_b32 v20, v25, v8
  v_and_b32 v21, v25, v9
  v_and_b32 v22, v25, v10
  v_and_b32 v23, v25, v11
  s_waitcnt vmcnt(14)
  s_nop 0
  v_mfma_f32_16x16x32_bf16 v[12:15], v[20:23], v[84:87], v[12:15]
  v_mfma_f32_16x16x32_bf16 v[16:19], v[20:23], v[88:91], v[16:19]
  s_mov_b32 s35, 417792
  buffer_load_dwordx4 v[84:87], v30, s[12:15], s35 offen offset:0 nt
  s_mov_b32 s35, 417792
  buffer_load_dwordx4 v[88:91], v30, s[12:15], s35 offen offset:1024 nt
  v_mov_b32_dpp v25, v45 row_newbcast:4 row_mask:0xf bank_mask:0x3
  v_mov_b32_dpp v25, v45 row_newbcast:12 row_mask:0xf bank_mask:0xc
  v_and_b32 v20, v25, v8
  v_and_b32 v21, v25, v9
  v_and_b32 v22, v25, v10
  v_and_b32 v23, v25, v11
  s_waitcnt vmcnt(14)
  s_nop 0
  v_mfma_f32_16x16x32_bf16 v[12:15], v[20:23], v[92:95], v[12:15]
  v_mfma_f32_16x16x32_bf16 v[16:19], v[20:23], v[96:99], v[16:19]
  s_mov_b32 s35, 425984
  buffer_load_dwordx4 v[92:95], v30, s[12:15], s35 offen offset:0 nt
  s_mov_b32 s35, 425984
  buffer_load_dwordx4 v[96:99], v30, s[12:15], s35 offen offset:1024 nt
  v_mov_b32_dpp v25, v45 row_newbcast:5 row_mask:0xf bank_mask:0x3
  v_mov_b32_dpp v25, v45 row_newbcast:13 row_mask:0xf bank_mask:0xc
  v_and_b32 v20, v25, v8
  v_and_b32 v21, v25, v9
  v_and_b32 v22, v25, v10
  v_and_b32 v23, v25, v11
  s_waitcnt vmcnt(14)
  s_nop 0
  v_mfma_f32_16x16x32_bf16 v[12:15], v[20:23], v[100:103], v[12:15]
  v_mfma_f32_16x16x32_bf16 v[16:19], v[20:23], v[104:107], v[16:19]
  s_mov_b32 s35, 434176
  buffer_load_dwordx4 v[100:103], v30, s[12:15], s35 offen offset:0 nt
  s_mov_b32 s35, 434176
  buffer_load_dwordx4 v[104:107], v30, s[12:15], s35 offen offset:1024 nt
  v_mov_b32_dpp v25, v45 row_newbcast:6 row_mask:0xf bank_mask:0x3
  v_mov_b32_dpp v25, v45 row_newbcast:14 row_mask:0xf bank_mask:0xc
  v_and_b32 v20, v25, v8
  v_and_b32 v21, v25, v9
  v_and_b32 v22, v25, v10
  v_and_b32 v23, v25, v11
  s_waitcnt vmcnt(14)
  s_nop 0
  v_mfma_f32_16x16x32_bf16 v[12:15], v[20:23], v[108:111], v[12:15]
  v_mfma_f32_16x16x32_bf16 v[16:19], v[20:23], v[112:115], v[16:19]
  s_mov_b32 s35, 442368
  buffer_load_dwordx4 v[108:111], v30, s[12:15], s35 offen offset:0 nt
  s_mov_b32 s35, 442368
  buffer_load_dwordx4 v[112:115], v30, s[12:15], s35 offen offset:1024 nt
  v_mov_b32_dpp v25, v45 row_newbcast:7 row_mask:0xf bank_mask:0x3
  v_mov_b32_dpp v25, v45 row_newbcast:15 row_mask:0xf bank_mask:0xc
  v_and_b32 v20, v25, v8
  v_and_b32 v21, v25, v9
  v_and_b32 v22, v25, v10
  v_and_b32 v23, v25, v11
  s_waitcnt vmcnt(14)
  s_nop 0
  v_mfma_f32_16x16x32_bf16 v[12:15], v[20:23], v[116:119], v[12:15]
  v_mfma_f32_16x16x32_bf16 v[16:19], v[20:23], v[120:123], v[16:19]
  s_mov_b32 s35, 450560
  buffer_load_dwordx4 v[116:119], v30, s[12:15], s35 offen offset:0 nt
  s_mov_b32 s35, 450560
  buffer_load_dwordx4 v[120:123], v30, s[12:15], s35 offen offset:1024 nt
  v_mov_b32_dpp v25, v46 row_newbcast:0 row_mask:0xf bank_mask:0x3
  v_mov_b32_dpp v25, v46 row_newbcast:8 row_mask:0xf bank_mask:0xc
  v_and_b32 v20, v25, v8
  v_and_b32 v21, v25, v9
  v_and_b32 v22, v25, v10
  v_and_b32 v23, v25, v11
  s_waitcnt vmcnt(14)
  s_nop 0
  v_mfma_f32_16x16x32_bf16 v[12:15], v[20:23], v[60:63], v[12:15]
  v_mfma_f32_16x16x32_bf16 v[16:19], v[20:23], v[64:67], v[16:19]
  s_mov_b32 s35, 458752
  buffer_load_dwordx4 v[60:63], v30, s[12:15], s35 offen offset:0 nt
  s_mov_b32 s35, 458752
  buffer_load_dwordx4 v[64:67], v30, s[12:15], s35 offen offset:1024 nt
  v_mov_b32_dpp v25, v46 row_newbcast:1 row_mask:0xf bank_mask:0x3
  v_mov_b32_dpp v25, v46 row_newbcast:9 row_mask:0xf bank_mask:0xc
  v_and_b32 v20, v25, v8
  v_and_b32 v21, v25, v9
  v_and_b32 v22, v25, v10
  v_and_b32 v23, v25, v11
  s_waitcnt vmcnt(14)
  s_nop 0
  v_mfma_f32_16x16x32_bf16 v[12:15], v[20:23], v[68:71], v[12:15]
  v_mfma_f32_16x16x32_bf16 v[16:19], v[20:23], v[72:75], v[16:19]
  s_mov_b32 s35, 466944
  buffer_load_dwordx4 v[68:71], v30, s[12:15], s35 offen offset:0 nt
  s_mov_b32 s35, 466944
  buffer_load_dwordx4 v[72:75], v30, s[12:15], s35 offen offset:1024 nt
  v_mov_b32_dpp v25, v46 row_newbcast:2 row_mask:0xf bank_mask:0x3
  v_mov_b32_dpp v25, v46 row_newbcast:10 row_mask:0xf bank_mask:0xc
  v_and_b32 v20, v25, v8
  v_and_b32 v21, v25, v9
  v_and_b32 v22, v25, v10
  v_and_b32 v23, v25, v11
  s_waitcnt vmcnt(14)
  s_nop 0
  v_mfma_f32_16x16x32_bf16 v[12:15], v[20:23], v[76:79], v[12:15]
  v_mfma_f32_16x16x32_bf16 v[16:19], v[20:23], v[80:83], v[16:19]
  s_mov_b32 s35, 475136
  buffer_load_dwordx4 v[76:79], v30, s[12:15], s35 offen offset:0 nt
  s_mov_b32 s35, 475136
  buffer_load_dwordx4 v[80:83], v30, s[12:15], s35 offen offset:1024 nt
  v_mov_b32_dpp v25, v46 row_newbcast:3 row_mask:0xf bank_mask:0x3
  v_mov_b32_dpp v25, v46 row_newbcast:11 row_mask:0xf bank_mask:0xc
  v_and_b32 v20, v25, v8
  v_and_b32 v21, v25, v9
  v_and_b32 v22, v25, v10
  v_and_b32 v23, v25, v11
  s_waitcnt vmcnt(14)
  s_nop 0
  v_mfma_f32_16x16x32_bf16 v[12:15], v[20:23], v[84:87], v[12:15]
  v_mfma_f32_16x16x32_bf16 v[16:19], v[20:23], v[88:91], v[16:19]
  s_mov_b32 s35, 483328
  buffer_load_dwordx4 v[84:87], v30, s[12:15], s35 offen offset:0 nt
  s_mov_b32 s35, 483328
  buffer_load_dwordx4 v[88:91], v30, s[12:15], s35 offen offset:1024 nt
  v_mov_b32_dpp v25, v46 row_newbcast:4 row_mask:0xf bank_mask:0x3
  v_mov_b32_dpp v25, v46 row_newbcast:12 row_mask:0xf bank_mask:0xc
  v_and_b32 v20, v25, v8
  v_and_b32 v21, v25, v9
  v_and_b32 v22, v25, v10
  v_and_b32 v23, v25, v11
  s_waitcnt vmcnt(14)
  s_nop 0
  v_mfma_f32_16x16x32_bf16 v[12:15], v[20:23], v[92:95], v[12:15]
  v_mfma_f32_16x16x32_bf16 v[16:19], v[20:23], v[96:99], v[16:19]
  s_mov_b32 s35, 491520
  buffer_load_dwordx4 v[92:95], v30, s[12:15], s35 offen offset:0 nt
  s_mov_b32 s35, 491520
  buffer_load_dwordx4 v[96:99], v30, s[12:15], s35 offen offset:1024 nt
  v_mov_b32_dpp v25, v46 row_newbcast:5 row_mask:0xf bank_mask:0x3
  v_mov_b32_dpp v25, v46 row_newbcast:13 row_mask:0xf bank_mask:0xc
  v_and_b32 v20, v25, v8
  v_and_b32 v21, v25, v9
  v_and_b32 v22, v25, v10
  v_and_b32 v23, v25, v11
  s_waitcnt vmcnt(14)
  s_nop 0
  v_mfma_f32_16x16x32_bf16 v[12:15], v[20:23], v[100:103], v[12:15]
  v_mfma_f32_16x16x32_bf16 v[16:19], v[20:23], v[104:107], v[16:19]
  s_mov_b32 s35, 499712
  buffer_load_dwordx4 v[100:103], v30, s[12:15], s35 offen offset:0 nt
  s_mov_b32 s35, 499712
  buffer_load_dwordx4 v[104:107], v30, s[12:15], s35 offen offset:1024 nt
  v_mov_b32_dpp v25, v46 row_newbcast:6 row_mask:0xf bank_mask:0x3
  v_mov_b32_dpp v25, v46 row_newbcast:14 row_mask:0xf bank_mask:0xc
  v_and_b32 v20, v25, v8
  v_and_b32 v21, v25, v9
  v_and_b32 v22, v25, v10
  v_and_b32 v23, v25, v11
  s_waitcnt vmcnt(14)
  s_nop 0
  v_mfma_f32_16x16x32_bf16 v[12:15], v[20:23], v[108:111], v[12:15]
  v_mfma_f32_16x16x32_bf16 v[16:19], v[20:23], v[112:115], v[16:19]
  s_mov_b32 s35, 507904
  buffer_load_dwordx4 v[108:111], v30, s[12:15], s35 offen offset:0 nt
  s_mov_b32 s35, 507904
  buffer_load_dwordx4 v[112:115], v30, s[12:15], s35 offen offset:1024 nt
  v_mov_b32_dpp v25, v46 row_newbcast:7 row_mask:0xf bank_mask:0x3
  v_mov_b32_dpp v25, v46 row_newbcast:15 row_mask:0xf bank_mask:0xc
  v_and_b32 v20, v25, v8
  v_and_b32 v21, v25, v9
  v_and_b32 v22, v25, v10
  v_and_b32 v23, v25, v11
  s_waitcnt vmcnt(14)
  s_nop 0
  v_mfma_f32_16x16x32_bf16 v[12:15], v[20:23], v[116:119], v[12:15]
  v_mfma_f32_16x16x32_bf16 v[16:19], v[20:23], v[120:123], v[16:19]
  s_mov_b32 s35, 516096
  buffer_load_dwordx4 v[116:119], v30, s[12:15], s35 offen offset:0 nt
  s_mov_b32 s35, 516096
  buffer_load_dwordx4 v[120:123], v30, s[12:15], s35 offen offset:1024 nt
  v_mov_b32_dpp v25, v47 row_newbcast:0 row_mask:0xf bank_mask:0x3
  v_mov_b32_dpp v25, v47 row_newbcast:8 row_mask:0xf bank_mask:0xc
  v_and_b32 v20, v25, v8
  v_and_b32 v21, v25, v9
  v_and_b32 v22, v25, v10
  v_and_b32 v23, v25, v11
  s_waitcnt vmcnt(14)
  s_nop 0
  v_mfma_f32_16x16x32_bf16 v[12:15], v[20:23], v[60:63], v[12:15]
  v_mfma_f32_16x16x32_bf16 v[16:19], v[20:23], v[64:67], v[16:19]
  buffer_load_dwordx4 v[60:63], v30, s[16:19], 0 offen offset:0 nt
  buffer_load_dwordx4 v[64:67], v30, s[16:19], 0 offen offset:1024 nt
  v_mov_b32_dpp v25, v47 row_newbcast:1 row_mask:0xf bank_mask:0x3
  v_mov_b32_dpp v25, v47 row_newbcast:9 row_mask:0xf bank_mask:0xc
  v_and_b32 v20, v25, v8
  v_and_b32 v21, v25, v9
  v_and_b32 v22, v25, v10
  v_and_b32 v23, v25, v11
  s_waitcnt vmcnt(14)
  s_nop 0
  v_mfma_f32_16x16x32_bf16 v[12:15], v[20:23], v[68:71], v[12:15]
  v_mfma_f32_16x16x32_bf16 v[16:19], v[20:23], v[72:75], v[16:19]
  s_mov_b32 s35, 8192
  buffer_load_dwordx4 v[68:71], v30, s[16:19], s35 offen offset:0 nt
  s_mov_b32 s35, 8192
  buffer_load_dwordx4 v[72:75], v30, s[16:19], s35 offen offset:1024 nt
  v_mov_b32_dpp v25, v47 row_newbcast:2 row_mask:0xf bank_mask:0x3
  v_mov_b32_dpp v25, v47 row_newbcast:10 row_mask:0xf bank_mask:0xc
  v_and_b32 v20, v25, v8
  v_and_b32 v21, v25, v9
  v_and_b32 v22, v25, v10
  v_and_b32 v23, v25, v11
  s_waitcnt vmcnt(14)
  s_nop 0
  v_mfma_f32_16x16x32_bf16 v[12:15], v[20:23], v[76:79], v[12:15]
  v_mfma_f32_16x16x32_bf16 v[16:19], v[20:23], v[80:83], v[16:19]
  s_mov_b32 s35, 16384
  buffer_load_dwordx4 v[76:79], v30, s[16:19], s35 offen offset:0 nt
  s_mov_b32 s35, 16384
  buffer_load_dwordx4 v[80:83], v30, s[16:19], s35 offen offset:1024 nt
  v_mov_b32_dpp v25, v47 row_newbcast:3 row_mask:0xf bank_mask:0x3
  v_mov_b32_dpp v25, v47 row_newbcast:11 row_mask:0xf bank_mask:0xc
  v_and_b32 v20, v25, v8
  v_and_b32 v21, v25, v9
  v_and_b32 v22, v25, v10
  v_and_b32 v23, v25, v11
  s_waitcnt vmcnt(14)
  s_nop 0
  v_mfma_f32_16x16x32_bf16 v[12:15], v[20:23], v[84:87], v[12:15]
  v_mfma_f32_16x16x32_bf16 v[16:19], v[20:23], v[88:91], v[16:19]
  s_mov_b32 s35, 24576
  buffer_load_dwordx4 v[84:87], v30, s[16:19], s35 offen offset:0 nt
  s_mov_b32 s35, 24576
  buffer_load_dwordx4 v[88:91], v30, s[16:19], s35 offen offset:1024 nt
  v_mov_b32_dpp v25, v47 row_newbcast:4 row_mask:0xf bank_mask:0x3
  v_mov_b32_dpp v25, v47 row_newbcast:12 row_mask:0xf bank_mask:0xc
  v_and_b32 v20, v25, v8
  v_and_b32 v21, v25, v9
  v_and_b32 v22, v25, v10
  v_and_b32 v23, v25, v11
  s_waitcnt vmcnt(14)
  s_nop 0
  v_mfma_f32_16x16x32_bf16 v[12:15], v[20:23], v[92:95], v[12:15]
  v_mfma_f32_16x16x32_bf16 v[16:19], v[20:23], v[96:99], v[16:19]
  s_mov_b32 s35, 32768
  buffer_load_dwordx4 v[92:95], v30, s[16:19], s35 offen offset:0 nt
  s_mov_b32 s35, 32768
  buffer_load_dwordx4 v[96:99], v30, s[16:19], s35 offen offset:1024 nt
  v_mov_b32_dpp v25, v47 row_newbcast:5 row_mask:0xf bank_mask:0x3
  v_mov_b32_dpp v25, v47 row_newbcast:13 row_mask:0xf bank_mask:0xc
  v_and_b32 v20, v25, v8
  v_and_b32 v21, v25, v9
  v_and_b32 v22, v25, v10
  v_and_b32 v23, v25, v11
  s_waitcnt vmcnt(14)
  s_nop 0
  v_mfma_f32_16x16x32_bf16 v[12:15], v[20:23], v[100:103], v[12:15]
  v_mfma_f32_16x16x32_bf16 v[16:19], v[20:23], v[104:107], v[16:19]
  s_mov_b32 s35, 40960
  buffer_load_dwordx4 v[100:103], v30, s[16:19], s35 offen offset:0 nt
  s_mov_b32 s35, 40960
  buffer_load_dwordx4 v[104:107], v30, s[16:19], s35 offen offset:1024 nt
  v_mov_b32_dpp v25, v47 row_newbcast:6 row_mask:0xf bank_mask:0x3
  v_mov_b32_dpp v25, v47 row_newbcast:14 row_mask:0xf bank_mask:0xc
  v_and_b32 v20, v25, v8
  v_and_b32 v21, v25, v9
  v_and_b32 v22, v25, v10
  v_and_b32 v23, v25, v11
  s_waitcnt vmcnt(14)
  s_nop 0
  v_mfma_f32_16x16x32_bf16 v[12:15], v[20:23], v[108:111], v[12:15]
  v_mfma_f32_16x16x32_bf16 v[16:19], v[20:23], v[112:115], v[16:19]
  s_mov_b32 s35, 49152
  buffer_load_dwordx4 v[108:111], v30, s[16:19], s35 offen offset:0 nt
  s_mov_b32 s35, 49152
  buffer_load_dwordx4 v[112:115], v30, s[16:19], s35 offen offset:1024 nt
  v_mov_b32_dpp v25, v47 row_newbcast:7 row_mask:0xf bank_mask:0x3
  v_mov_b32_dpp v25, v47 row_newbcast:15 row_mask:0xf bank_mask:0xc
  v_and_b32 v20, v25, v8
  v_and_b32 v21, v25, v9
  v_and_b32 v22, v25, v10
  v_and_b32 v23, v25, v11
  s_waitcnt vmcnt(14)
  s_nop 0
  v_mfma_f32_16x16x32_bf16 v[12:15], v[20:23], v[116:119], v[12:15]
  v_mfma_f32_16x16x32_bf16 v[16:19], v[20:23], v[120:123], v[16:19]
  s_mov_b32 s35, 57344
  buffer_load_dwordx4 v[116:119], v30, s[16:19], s35 offen offset:0 nt
  s_mov_b32 s35, 57344
  buffer_load_dwordx4 v[120:123], v30, s[16:19], s35 offen offset:1024 nt
  v_and_b32 v2, 63, v0
  v_cmp_gt_u32 vcc, 32, v2
  v_lshlrev_b32 v1, 4, v0
  v_add_u32 v1, s40, v1
  s_nop 7
  v_cndmask_b32 v20, v16, v12, vcc
  v_cndmask_b32 v21, v17, v13, vcc
  v_cndmask_b32 v22, v18, v14, vcc
  v_cndmask_b32 v23, v19, v15, vcc
  ds_write_b128 v1, v[20:23]
  s_waitcnt lgkmcnt(0)
  s_barrier
  s_mul_i32 s40, s33, 4224
  v_and_b32 v1, 3, v2
  v_lshlrev_b32 v1, 3, v1
  v_add_u32 v1, s40, v1
  ds_read_b64 v[40:41], v1 offset:4096
  v_lshlrev_b32 v3, 4, v2
  v_add_u32 v3, s40, v3
  ds_read_b128 v[44:47], v3 offset:0
  ds_read_b128 v[48:51], v3 offset:1024
  ds_read_b128 v[52:55], v3 offset:2048
  ds_read_b128 v[56:59], v3 offset:3072
  s_waitcnt lgkmcnt(4)
  v_mov_b32 v42, v40
  s_nop 1
  v_max_f32_dpp v42, v42, v42 quad_perm:[1,0,3,2] row_mask:0xf bank_mask:0xf
  s_nop 1
  v_max_f32_dpp v42, v42, v42 quad_perm:[2,3,0,1] row_mask:0xf bank_mask:0xf
  s_nop 1
  v_sub_f32 v40, v40, v42
  v_exp_f32 v40, v40
  s_nop 0
  v_mul_f32 v41, v40, v41
  s_nop 1
  v_add_f32_dpp v41, v41, v41 quad_perm:[1,0,3,2] row_mask:0xf bank_mask:0xf
  s_nop 1
  v_add_f32_dpp v41, v41, v41 quad_perm:[2,3,0,1] row_mask:0xf bank_mask:0xf
  s_nop 1
  v_rcp_f32 v41, v41
  s_nop 0
  v_mul_f32 v40, v40, v41
  s_nop 0
  v_readlane_b32 s44, v40, 0
  v_readlane_b32 s45, v40, 1
  v_readlane_b32 s46, v40, 2
  v_readlane_b32 s47, v40, 3
  v_and_b32 v1, 15, v2
  v_lshlrev_b32 v1, 4, v1
  v_lshrrev_b32 v3, 4, v2
  v_lshl_add_u32 v1, v3, 3, v1
  s_lshl_b32 s43, s33, 8
  s_add_u32 s43, s43, s2
  s_lshl_b32 s43, s43, 8
  s_waitcnt lgkmcnt(0)
  v_mul_f32 v20, s44, v44
  v_mul_f32 v21, s44, v45
  v_mul_f32 v22, s44, v46
  v_mul_f32 v23, s44, v47
  v_fmac_f32 v20, s45, v48
  v_fmac_f32 v21, s45, v49
  v_fmac_f32 v22, s45, v50
  v_fmac_f32 v23, s45, v51
  v_fmac_f32 v20, s46, v52
  v_fmac_f32 v21, s46, v53
  v_fmac_f32 v22, s46, v54
  v_fmac_f32 v23, s46, v55
  v_fmac_f32 v20, s47, v56
  v_fmac_f32 v21, s47, v57
  v_fmac_f32 v22, s47, v58
  v_fmac_f32 v23, s47, v59
  v_mov_b32 v44, v20
  v_mov_b32 v45, v21
  v_mov_b32 v46, v22
  v_mov_b32 v47, v23
  s_nop 1
  v_permlane32_swap_b32 v20, v44
  v_permlane32_swap_b32 v21, v45
  v_permlane32_swap_b32 v22, v46
  v_permlane32_swap_b32 v23, v47
  s_nop 1
  v_add_f32 v20, v20, v44
  v_add_f32 v21, v21, v45
  v_add_f32 v22, v22, v46
  v_add_f32 v23, v23, v47
  v_cvt_pk_bf16_f32 v40, v20, v21
  v_cvt_pk_bf16_f32 v41, v22, v23
  s_mov_b64 exec, 0xffffffff
  buffer_store_dwordx2 v[40:41], v1, s[28:31], s43 offen
L_end:
  s_endpgm
.section .rodata,"a"
.p2align 6
.amdhsa_kernel standalone__mha_softmax__sampling_kernel
  .amdhsa_next_free_vgpr 124
  .amdhsa_next_free_sgpr 64
  .amdhsa_accum_offset 124
  .amdhsa_group_segment_fixed_size 0
  .amdhsa_kernarg_size 48
  .amdhsa_user_sgpr_count 2
  .amdhsa_user_sgpr_kernarg_segment_ptr 1
  .amdhsa_system_sgpr_workgroup_id_x 1
.end_amdhsa_kernel
```
